```python
import torch

def _softmax(x, axis=-1):
    return torch.softmax(x, dim=axis)
def _gelu(x):
    return torch.nn.functional.gelu(x, approximate="tanh")
def _silu(x):
    return torch.nn.functional.silu(x)
def _sigmoid(x):
    return torch.sigmoid(x)
def _layernorm(x, axis=-1, eps=1e-5):
    m = x.mean(dim=axis, keepdim=True)
    v = x.var(dim=axis, keepdim=True, unbiased=False)
    return (x - m) / torch.sqrt(v + eps)
def _scatter_add(tgt, idx, src, axis=0):
    return tgt.clone().index_add_(axis, idx, src)
def _segment_sum(src, seg, n):
    out = torch.zeros((n,) + src.shape[1:], dtype=src.dtype)
    return out.index_add_(0, seg, src)
def _pad(x, pw):
    flat = tuple(v for pair in reversed(pw) for v in pair)
    return torch.nn.functional.pad(x, flat)

kernel_name = 'standalone__mha_softmax__near_ridge'

def setup_inputs():

    _w = (lambda a: (lambda t: t.to(torch.bfloat16) if t.is_floating_point() else t)(torch.as_tensor(a)))
    B, H, Sq, Sk, D = 16, 32, 256, 256, 192
    return {
        "q": _w((lambda *s: torch.randn(*s, dtype=torch.bfloat16) * 0.8)(B, H, Sq, D)),
        "k": _w((lambda *s: torch.randn(*s, dtype=torch.bfloat16) * 0.8)(B, H, Sk, D)),
        "v": _w((lambda *s: torch.randn(*s, dtype=torch.bfloat16) * 0.05)(B, H, Sk, D)),
    }

def reference(q, k, v):
    scale = q.shape[-1] ** -0.5
    scores = torch.einsum("bhqd,bhkd->bhqk", q, k) * scale
    p = _softmax(scores, axis=-1)
    return torch.einsum("bhqk,bhkd->bhqd", p, v)
```

```asm
; @launch grid=(256,1,1) block=(512,1,1) lds=163840
.amdgcn_target "amdgcn-amd-amdhsa--gfx950"
.text
.globl standalone__mha_softmax__near_ridge_kernel
.p2align 8
.type standalone__mha_softmax__near_ridge_kernel,@function
standalone__mha_softmax__near_ridge_kernel:
    s_cmp_ge_u32 s2, 256
    s_cbranch_scc1 L_end
    s_load_dwordx4 s[4:7], s[0:1], 0
    s_load_dwordx4 s[8:11], s[0:1], 16
    v_lshrrev_b32 v1, 6, v0
    v_and_b32 v2, 63, v0
    v_readfirstlane_b32 s3, v1
    v_and_b32 v3, 31, v2
    v_lshrrev_b32 v4, 5, v2
    v_lshrrev_b32 v5, 3, v2
    v_lshl_add_u32 v5, v1, 3, v5
    v_bfe_u32 v6, v2, 4, 1
    v_lshlrev_b32 v6, 2, v6
    v_lshl_or_b32 v6, v4, 1, v6
    v_and_b32 v7, 1, v1
    v_or_b32 v6, v6, v7
    v_and_b32 v7, 7, v2
    v_xor_b32 v6, v6, v7
    v_mul_u32_u24 v5, 384, v5
    v_lshl_add_u32 v244, v6, 4, v5
    s_lshl_b32 s28, s3, 10
    s_mul_i32 s29, s2, 98304
    s_add_u32 s30, s29, 25165824
    s_waitcnt lgkmcnt(0)
    s_mov_b32 s12, s4
    s_mov_b32 s13, s5
    s_mov_b32 s14, 50331648
    s_mov_b32 s15, 0x00020000
    s_mov_b32 s16, s6
    s_mov_b32 s17, s7
    s_mov_b32 s18, 50331648
    s_mov_b32 s19, 0x00020000
    s_mov_b32 s20, s8
    s_mov_b32 s21, s9
    s_mov_b32 s22, 50331648
    s_mov_b32 s23, 0x00020000
    s_mov_b32 s24, s10
    s_mov_b32 s25, s11
    s_mov_b32 s26, 50331648
    s_mov_b32 s27, 0x00020000
    s_lshl_b32 s9, s3, 13
    s_add_u32 s36, s9, 98304
    s_add_u32 s4, s36, 4096
    s_mul_i32 s5, s3, 9216
    s_and_b32 s6, s3, 1
    s_lshl_b32 s6, s6, 4
    s_xor_b32 s7, s6, 16
    s_add_u32 m0, s28, 0
    s_add_u32 s31, s29, 0
    buffer_load_dwordx4 v244, s[16:19], s31 offen offset:0 nt lds
    s_add_u32 m0, s28, 8064
    s_add_u32 s31, s29, 0
    buffer_load_dwordx4 v244, s[16:19], s31 offen offset:128 nt lds
    s_add_u32 m0, s28, 16128
    s_add_u32 s31, s29, 0
    buffer_load_dwordx4 v244, s[16:19], s31 offen offset:256 nt lds
    v_xor_b32 v254, s6, v244
    s_add_u32 m0, s36, 0
    s_add_u32 s31, s29, s5
    s_add_u32 s31, s31, 0
    buffer_load_dwordx4 v254, s[12:15], s31 offen nt lds
    v_xor_b32 v254, s7, v244
    s_add_u32 m0, s36, 1024
    s_add_u32 s31, s29, s5
    s_add_u32 s31, s31, 3072
    buffer_load_dwordx4 v254, s[12:15], s31 offen nt lds
    v_xor_b32 v254, s6, v244
    s_add_u32 m0, s36, 2048
    s_add_u32 s31, s29, s5
    s_add_u32 s31, s31, 6144
    buffer_load_dwordx4 v254, s[12:15], s31 offen nt lds
    v_xor_b32 v254, s7, v244
    s_add_u32 m0, s36, 3072
    s_add_u32 s31, s29, s5
    s_add_u32 s31, s31, 9216
    buffer_load_dwordx4 v254, s[12:15], s31 offen nt lds
    v_bfe_u32 v5, v3, 1, 1
    v_lshlrev_b32 v5, 2, v5
    v_bfe_u32 v6, v3, 2, 1
    v_lshl_or_b32 v5, v6, 1, v5
    v_bfe_u32 v6, v3, 3, 1
    v_or_b32 v5, v5, v6
    v_xor_b32 v5, v5, v4
    v_lshlrev_b32 v5, 4, v5
    v_lshl_add_u32 v249, v3, 7, v5
    v_bfe_u32 v5, v2, 2, 2
    v_lshl_add_u32 v6, v4, 2, v5
    v_lshlrev_b32 v6, 7, v6
    v_bfe_u32 v7, v2, 4, 1
    v_lshlrev_b32 v7, 1, v7
    v_bfe_u32 v8, v2, 1, 1
    v_or_b32 v7, v7, v8
    v_bfe_u32 v8, v2, 3, 1
    v_lshlrev_b32 v8, 2, v8
    v_lshl_or_b32 v8, v4, 1, v8
    v_xor_b32 v7, v7, v8
    v_lshl_add_u32 v6, v7, 4, v6
    v_and_b32 v7, 1, v2
    v_lshl_add_u32 v251, v7, 3, v6
    s_mov_b32 s32, 0xbdd53b95
    s_mul_i32 s37, s3, 12288
    s_add_u32 s39, s29, s37
    s_add_u32 s33, s30, s37
    v_and_b32 v5, 7, v3
    v_lshlrev_b32 v240, 7, v3
    v_lshl_add_u32 v240, v5, 4, v240
    v_lshl_add_u32 v240, v4, 3, v240
    v_add_u32 v240, s36, v240
    v_lshlrev_b32 v241, 4, v2
    v_add_u32 v241, s36, v241
    v_lshrrev_b32 v5, 3, v2
    v_and_b32 v6, 7, v2
    v_xor_b32 v6, v6, v5
    v_mul_u32_u24 v242, 384, v5
    v_lshl_add_u32 v242, v6, 4, v242
    s_waitcnt vmcnt(4)
    s_barrier
    v_xor_b32 v254, s6, v244
    s_add_u32 m0, s4, 0
    s_add_u32 s31, s29, s5
    s_add_u32 s31, s31, 128
    buffer_load_dwordx4 v254, s[12:15], s31 offen nt lds
    v_xor_b32 v254, s7, v244
    s_add_u32 m0, s4, 1024
    s_add_u32 s31, s29, s5
    s_add_u32 s31, s31, 3200
    buffer_load_dwordx4 v254, s[12:15], s31 offen nt lds
    v_xor_b32 v254, s6, v244
    s_add_u32 m0, s4, 2048
    s_add_u32 s31, s29, s5
    s_add_u32 s31, s31, 6272
    buffer_load_dwordx4 v254, s[12:15], s31 offen nt lds
    v_xor_b32 v254, s7, v244
    s_add_u32 m0, s4, 3072
    s_add_u32 s31, s29, s5
    s_add_u32 s31, s31, 9344
    buffer_load_dwordx4 v254, s[12:15], s31 offen nt lds
    s_waitcnt vmcnt(4)
    v_add_u32 v176, s36, v249
    v_xor_b32 v177, 32, v176
    v_xor_b32 v178, 64, v176
    v_xor_b32 v179, 96, v176
    ds_read_b128 v[128:131], v176
    ds_read_b128 v[132:135], v177
    ds_read_b128 v[136:139], v178
    ds_read_b128 v[140:143], v179
    v_add_u32 v245, 0, v249
    v_xor_b32 v246, 32, v245
    v_xor_b32 v247, 64, v245
    v_xor_b32 v248, 96, v245
    ds_read_b128 v[224:227], v245 offset:0
    ds_read_b128 v[228:231], v246 offset:0
    ds_read_b128 v[232:235], v247 offset:0
    s_waitcnt lgkmcnt(3)
    s_waitcnt lgkmcnt(2)
    v_mfma_f32_32x32x16_bf16 v[0:15], v[224:227], v[128:131], 0
    ds_read_b128 v[236:239], v248 offset:0
    s_waitcnt lgkmcnt(2)
    v_mfma_f32_32x32x16_bf16 v[0:15], v[228:231], v[132:135], v[0:15]
    ds_read_b128 v[224:227], v245 offset:4096
    v_xor_b32 v254, s6, v244
    s_add_u32 m0, s36, 0
    s_add_u32 s31, s29, s5
    s_add_u32 s31, s31, 256
    buffer_load_dwordx4 v254, s[12:15], s31 offen nt lds
    s_waitcnt lgkmcnt(2)
    v_mfma_f32_32x32x16_bf16 v[0:15], v[232:235], v[136:139], v[0:15]
    ds_read_b128 v[228:231], v246 offset:4096
    v_xor_b32 v254, s7, v244
    s_add_u32 m0, s36, 1024
    s_add_u32 s31, s29, s5
    s_add_u32 s31, s31, 3328
    buffer_load_dwordx4 v254, s[12:15], s31 offen nt lds
    s_waitcnt lgkmcnt(2)
    v_mfma_f32_32x32x16_bf16 v[0:15], v[236:239], v[140:143], v[0:15]
    ds_read_b128 v[232:235], v247 offset:4096
    v_xor_b32 v254, s6, v244
    s_add_u32 m0, s36, 2048
    s_add_u32 s31, s29, s5
    s_add_u32 s31, s31, 6400
    buffer_load_dwordx4 v254, s[12:15], s31 offen nt lds
    s_waitcnt lgkmcnt(2)
    v_mfma_f32_32x32x16_bf16 v[16:31], v[224:227], v[128:131], 0
    ds_read_b128 v[236:239], v248 offset:4096
    v_xor_b32 v254, s7, v244
    s_add_u32 m0, s36, 3072
    s_add_u32 s31, s29, s5
    s_add_u32 s31, s31, 9472
    buffer_load_dwordx4 v254, s[12:15], s31 offen nt lds
    s_waitcnt lgkmcnt(2)
    v_mfma_f32_32x32x16_bf16 v[16:31], v[228:231], v[132:135], v[16:31]
    ds_read_b128 v[224:227], v245 offset:8192
    s_waitcnt vmcnt(4)
    v_add_u32 v176, s4, v249
    v_xor_b32 v177, 32, v176
    v_xor_b32 v178, 64, v176
    v_xor_b32 v179, 96, v176
    ds_read_b128 v[144:147], v176
    ds_read_b128 v[148:151], v177
    ds_read_b128 v[152:155], v178
    ds_read_b128 v[156:159], v179
    s_waitcnt lgkmcnt(6)
    v_mfma_f32_32x32x16_bf16 v[16:31], v[232:235], v[136:139], v[16:31]
    ds_read_b128 v[228:231], v246 offset:8192
    s_add_u32 m0, s28, 24576
    s_add_u32 s31, s29, 24576
    buffer_load_dwordx4 v244, s[16:19], s31 offen offset:0 nt lds
    s_waitcnt lgkmcnt(6)
    v_mfma_f32_32x32x16_bf16 v[16:31], v[236:239], v[140:143], v[16:31]
    ds_read_b128 v[232:235], v247 offset:8192
    s_add_u32 m0, s28, 32640
    s_add_u32 s31, s29, 24576
    buffer_load_dwordx4 v244, s[16:19], s31 offen offset:128 nt lds
    s_waitcnt lgkmcnt(2)
    s_waitcnt lgkmcnt(6)
    v_mfma_f32_32x32x16_bf16 v[0:15], v[224:227], v[144:147], v[0:15]
    ds_read_b128 v[236:239], v248 offset:8192
    s_add_u32 m0, s28, 40704
    s_add_u32 s31, s29, 24576
    buffer_load_dwordx4 v244, s[16:19], s31 offen offset:256 nt lds
    s_waitcnt lgkmcnt(2)
    v_mfma_f32_32x32x16_bf16 v[0:15], v[228:231], v[148:151], v[0:15]
    ds_read_b128 v[224:227], v245 offset:12288
    s_waitcnt lgkmcnt(2)
    v_mfma_f32_32x32x16_bf16 v[0:15], v[232:235], v[152:155], v[0:15]
    ds_read_b128 v[228:231], v246 offset:12288
    s_waitcnt lgkmcnt(2)
    v_mfma_f32_32x32x16_bf16 v[0:15], v[236:239], v[156:159], v[0:15]
    ds_read_b128 v[232:235], v247 offset:12288
    s_waitcnt lgkmcnt(2)
    v_mfma_f32_32x32x16_bf16 v[16:31], v[224:227], v[144:147], v[16:31]
    ds_read_b128 v[236:239], v248 offset:12288
    s_waitcnt lgkmcnt(2)
    v_mfma_f32_32x32x16_bf16 v[16:31], v[228:231], v[148:151], v[16:31]
    ds_read_b128 v[224:227], v245 offset:16384
    s_waitcnt vmcnt(3)
    v_add_u32 v176, s36, v249
    v_xor_b32 v177, 32, v176
    v_xor_b32 v178, 64, v176
    v_xor_b32 v179, 96, v176
    ds_read_b128 v[160:163], v176
    ds_read_b128 v[164:167], v177
    ds_read_b128 v[168:171], v178
    ds_read_b128 v[172:175], v179
    s_waitcnt lgkmcnt(6)
    v_mfma_f32_32x32x16_bf16 v[16:31], v[232:235], v[152:155], v[16:31]
    ds_read_b128 v[228:231], v246 offset:16384
    s_waitcnt lgkmcnt(6)
    v_mfma_f32_32x32x16_bf16 v[16:31], v[236:239], v[156:159], v[16:31]
    ds_read_b128 v[232:235], v247 offset:16384
    s_waitcnt lgkmcnt(2)
    s_waitcnt lgkmcnt(6)
    v_mfma_f32_32x32x16_bf16 v[0:15], v[224:227], v[160:163], v[0:15]
    ds_read_b128 v[236:239], v248 offset:16384
    s_waitcnt lgkmcnt(2)
    v_mfma_f32_32x32x16_bf16 v[0:15], v[228:231], v[164:167], v[0:15]
    ds_read_b128 v[224:227], v245 offset:20480
    s_waitcnt lgkmcnt(2)
    v_mfma_f32_32x32x16_bf16 v[0:15], v[232:235], v[168:171], v[0:15]
    ds_read_b128 v[228:231], v246 offset:20480
    s_waitcnt lgkmcnt(2)
    v_mfma_f32_32x32x16_bf16 v[0:15], v[236:239], v[172:175], v[0:15]
    ds_read_b128 v[232:235], v247 offset:20480
    s_waitcnt lgkmcnt(2)
    v_mfma_f32_32x32x16_bf16 v[16:31], v[224:227], v[160:163], v[16:31]
    ds_read_b128 v[236:239], v248 offset:20480
    s_waitcnt lgkmcnt(2)
    v_mfma_f32_32x32x16_bf16 v[16:31], v[228:231], v[164:167], v[16:31]
    s_waitcnt vmcnt(0)
    s_barrier
    v_add_u32 v245, 24576, v249
    v_xor_b32 v246, 32, v245
    v_xor_b32 v247, 64, v245
    v_xor_b32 v248, 96, v245
    ds_read_b128 v[224:227], v245 offset:0
    s_add_u32 m0, s28, 49152
    s_add_u32 s31, s29, 49152
    buffer_load_dwordx4 v244, s[16:19], s31 offen offset:0 nt lds
    s_waitcnt lgkmcnt(2)
    v_mfma_f32_32x32x16_bf16 v[16:31], v[232:235], v[168:171], v[16:31]
    ds_read_b128 v[228:231], v246 offset:0
    s_add_u32 m0, s28, 57216
    s_add_u32 s31, s29, 49152
    buffer_load_dwordx4 v244, s[16:19], s31 offen offset:128 nt lds
    v_xor_b32 v254, s6, v244
    s_add_u32 m0, s4, 0
    s_add_u32 s31, s30, s5
    s_add_u32 s31, s31, 128
    buffer_load_dwordx4 v254, s[12:15], s31 offen nt lds
    s_waitcnt lgkmcnt(2)
    v_mfma_f32_32x32x16_bf16 v[16:31], v[236:239], v[172:175], v[16:31]
    ds_read_b128 v[232:235], v247 offset:0
    s_add_u32 m0, s28, 65280
    s_add_u32 s31, s29, 49152
    buffer_load_dwordx4 v244, s[16:19], s31 offen offset:256 nt lds
    v_xor_b32 v254, s7, v244
    s_add_u32 m0, s4, 1024
    s_add_u32 s31, s30, s5
    s_add_u32 s31, s31, 3200
    buffer_load_dwordx4 v254, s[12:15], s31 offen nt lds
    s_waitcnt lgkmcnt(2)
    v_mfma_f32_32x32x16_bf16 v[32:47], v[224:227], v[128:131], 0
    ds_read_b128 v[236:239], v248 offset:0
    v_max3_f32 v208, v0, v1, v2
    v_max3_f32 v208, v208, v3, v4
    v_max3_f32 v208, v208, v5, v6
    v_xor_b32 v254, s6, v244
    s_add_u32 m0, s4, 2048
    s_add_u32 s31, s30, s5
    s_add_u32 s31, s31, 6272
    buffer_load_dwordx4 v254, s[12:15], s31 offen nt lds
    s_waitcnt lgkmcnt(2)
    v_mfma_f32_32x32x16_bf16 v[32:47], v[228:231], v[132:135], v[32:47]
    ds_read_b128 v[224:227], v245 offset:8192
    v_max3_f32 v208, v208, v7, v8
    v_max3_f32 v208, v208, v9, v10
    v_xor_b32 v254, s7, v244
    s_add_u32 m0, s4, 3072
    s_add_u32 s31, s30, s5
    s_add_u32 s31, s31, 9344
    buffer_load_dwordx4 v254, s[12:15], s31 offen nt lds
    s_waitcnt lgkmcnt(2)
    v_mfma_f32_32x32x16_bf16 v[32:47], v[232:235], v[136:139], v[32:47]
    ds_read_b128 v[228:231], v246 offset:8192
    v_max3_f32 v208, v208, v11, v12
    v_max3_f32 v208, v208, v13, v14
    s_waitcnt lgkmcnt(2)
    v_mfma_f32_32x32x16_bf16 v[32:47], v[236:239], v[140:143], v[32:47]
    ds_read_b128 v[232:235], v247 offset:8192
    v_max_f32 v208, v208, v15
    v_mul_f32 v208, s32, v208
    s_waitcnt lgkmcnt(2)
    v_mfma_f32_32x32x16_bf16 v[32:47], v[224:227], v[144:147], v[32:47]
    ds_read_b128 v[236:239], v248 offset:8192
    v_max3_f32 v209, v16, v17, v18
    v_max3_f32 v209, v209, v19, v20
    v_max3_f32 v209, v209, v21, v22
    v_fmamk_f32 v0, v0, 0x3dd53b95, v208
    v_fmamk_f32 v1, v1, 0x3dd53b95, v208
    v_exp_f32 v0, v0
    s_waitcnt lgkmcnt(2)
    v_mfma_f32_32x32x16_bf16 v[32:47], v[228:231], v[148:151], v[32:47]
    ds_read_b128 v[224:227], v245 offset:16384
    v_max3_f32 v209, v209, v23, v24
    v_max3_f32 v209, v209, v25, v26
    v_fmamk_f32 v2, v2, 0x3dd53b95, v208
    v_exp_f32 v1, v1
    v_fmamk_f32 v3, v3, 0x3dd53b95, v208
    s_waitcnt lgkmcnt(2)
    v_mfma_f32_32x32x16_bf16 v[32:47], v[232:235], v[152:155], v[32:47]
    ds_read_b128 v[228:231], v246 offset:16384
    v_max3_f32 v209, v209, v27, v28
    v_max3_f32 v209, v209, v29, v30
    v_exp_f32 v2, v2
    v_fmamk_f32 v4, v4, 0x3dd53b95, v208
    s_waitcnt lgkmcnt(2)
    v_mfma_f32_32x32x16_bf16 v[32:47], v[236:239], v[156:159], v[32:47]
    ds_read_b128 v[232:235], v247 offset:16384
    v_max_f32 v209, v209, v31
    v_mul_f32 v209, s32, v209
    v_exp_f32 v3, v3
    v_fmamk_f32 v5, v5, 0x3dd53b95, v208
    v_exp_f32 v4, v4
    s_waitcnt lgkmcnt(2)
    v_mfma_f32_32x32x16_bf16 v[32:47], v[224:227], v[160:163], v[32:47]
    ds_read_b128 v[236:239], v248 offset:16384
    v_fmamk_f32 v6, v6, 0x3dd53b95, v208
    v_exp_f32 v5, v5
    v_fmamk_f32 v7, v7, 0x3dd53b95, v208
    v_fmamk_f32 v16, v16, 0x3dd53b95, v209
    v_fmamk_f32 v17, v17, 0x3dd53b95, v209
    v_exp_f32 v16, v16
    s_waitcnt lgkmcnt(2)
    v_mfma_f32_32x32x16_bf16 v[32:47], v[228:231], v[164:167], v[32:47]
    ds_read_b128 v[224:227], v245 offset:4096
    v_exp_f32 v6, v6
    v_fmamk_f32 v8, v8, 0x3dd53b95, v208
    v_fmamk_f32 v18, v18, 0x3dd53b95, v209
    v_exp_f32 v17, v17
    v_fmamk_f32 v19, v19, 0x3dd53b95, v209
    s_waitcnt lgkmcnt(2)
    v_mfma_f32_32x32x16_bf16 v[32:47], v[232:235], v[168:171], v[32:47]
    ds_read_b128 v[228:231], v246 offset:4096
    v_exp_f32 v7, v7
    v_fmamk_f32 v9, v9, 0x3dd53b95, v208
    v_exp_f32 v8, v8
    v_exp_f32 v18, v18
    v_fmamk_f32 v20, v20, 0x3dd53b95, v209
    s_waitcnt lgkmcnt(2)
    v_mfma_f32_32x32x16_bf16 v[32:47], v[236:239], v[172:175], v[32:47]
    ds_read_b128 v[232:235], v247 offset:4096
    v_fmamk_f32 v10, v10, 0x3dd53b95, v208
    v_exp_f32 v9, v9
    v_fmamk_f32 v11, v11, 0x3dd53b95, v208
    v_exp_f32 v19, v19
    v_fmamk_f32 v21, v21, 0x3dd53b95, v209
    v_exp_f32 v20, v20
    s_waitcnt lgkmcnt(2)
    v_mfma_f32_32x32x16_bf16 v[48:63], v[224:227], v[128:131], 0
    ds_read_b128 v[236:239], v248 offset:4096
    v_exp_f32 v10, v10
    v_fmamk_f32 v12, v12, 0x3dd53b95, v208
    v_fmamk_f32 v22, v22, 0x3dd53b95, v209
    v_exp_f32 v21, v21
    v_fmamk_f32 v23, v23, 0x3dd53b95, v209
    s_waitcnt lgkmcnt(2)
    v_mfma_f32_32x32x16_bf16 v[48:63], v[228:231], v[132:135], v[48:63]
    ds_read_b128 v[224:227], v245 offset:12288
    v_exp_f32 v11, v11
    v_fmamk_f32 v13, v13, 0x3dd53b95, v208
    v_exp_f32 v12, v12
    v_exp_f32 v22, v22
    v_fmamk_f32 v24, v24, 0x3dd53b95, v209
    s_waitcnt lgkmcnt(2)
    v_mfma_f32_32x32x16_bf16 v[48:63], v[232:235], v[136:139], v[48:63]
    ds_read_b128 v[228:231], v246 offset:12288
    v_fmamk_f32 v14, v14, 0x3dd53b95, v208
    v_exp_f32 v13, v13
    v_fmamk_f32 v15, v15, 0x3dd53b95, v208
    v_exp_f32 v23, v23
    v_fmamk_f32 v25, v25, 0x3dd53b95, v209
    v_exp_f32 v24, v24
    s_waitcnt lgkmcnt(2)
    v_mfma_f32_32x32x16_bf16 v[48:63], v[236:239], v[140:143], v[48:63]
    ds_read_b128 v[232:235], v247 offset:12288
    v_exp_f32 v14, v14
    v_exp_f32 v15, v15
    v_fmamk_f32 v26, v26, 0x3dd53b95, v209
    v_exp_f32 v25, v25
    v_fmamk_f32 v27, v27, 0x3dd53b95, v209
    s_waitcnt lgkmcnt(2)
    v_mfma_f32_32x32x16_bf16 v[48:63], v[224:227], v[144:147], v[48:63]
    ds_read_b128 v[236:239], v248 offset:12288
    v_max3_f32 v210, v32, v33, v34
    v_max3_f32 v210, v210, v35, v36
    v_max3_f32 v210, v210, v37, v38
    v_exp_f32 v26, v26
    v_fmamk_f32 v28, v28, 0x3dd53b95, v209
    s_waitcnt lgkmcnt(2)
    v_mfma_f32_32x32x16_bf16 v[48:63], v[228:231], v[148:151], v[48:63]
    ds_read_b128 v[224:227], v245 offset:20480
    v_max3_f32 v210, v210, v39, v40
    v_max3_f32 v210, v210, v41, v42
    v_exp_f32 v27, v27
    v_fmamk_f32 v29, v29, 0x3dd53b95, v209
    v_exp_f32 v28, v28
    s_waitcnt lgkmcnt(2)
    v_mfma_f32_32x32x16_bf16 v[48:63], v[232:235], v[152:155], v[48:63]
    ds_read_b128 v[228:231], v246 offset:20480
    v_max3_f32 v210, v210, v43, v44
    v_max3_f32 v210, v210, v45, v46
    v_fmamk_f32 v30, v30, 0x3dd53b95, v209
    v_exp_f32 v29, v29
    v_fmamk_f32 v31, v31, 0x3dd53b95, v209
    s_waitcnt lgkmcnt(2)
    v_mfma_f32_32x32x16_bf16 v[48:63], v[236:239], v[156:159], v[48:63]
    ds_read_b128 v[232:235], v247 offset:20480
    v_max_f32 v210, v210, v47
    v_mul_f32 v210, s32, v210
    v_exp_f32 v30, v30
    v_exp_f32 v31, v31
    s_waitcnt lgkmcnt(2)
    v_mfma_f32_32x32x16_bf16 v[48:63], v[224:227], v[160:163], v[48:63]
    ds_read_b128 v[236:239], v248 offset:20480
    v_fmamk_f32 v32, v32, 0x3dd53b95, v210
    v_fmamk_f32 v33, v33, 0x3dd53b95, v210
    v_exp_f32 v32, v32
    s_waitcnt lgkmcnt(2)
    v_mfma_f32_32x32x16_bf16 v[48:63], v[228:231], v[164:167], v[48:63]
    s_waitcnt vmcnt(3)
    s_barrier
    v_add_u32 v245, 49152, v249
    v_xor_b32 v246, 32, v245
    v_xor_b32 v247, 64, v245
    v_xor_b32 v248, 96, v245
    ds_read_b128 v[224:227], v245 offset:0
    s_add_u32 m0, s28, 73728
    s_add_u32 s31, s29, 73728
    buffer_load_dwordx4 v244, s[16:19], s31 offen offset:0 nt lds
    v_fmamk_f32 v34, v34, 0x3dd53b95, v210
    v_exp_f32 v33, v33
    v_fmamk_f32 v35, v35, 0x3dd53b95, v210
    s_waitcnt lgkmcnt(2)
    v_mfma_f32_32x32x16_bf16 v[48:63], v[232:235], v[168:171], v[48:63]
    ds_read_b128 v[228:231], v246 offset:0
    s_add_u32 m0, s28, 81792
    s_add_u32 s31, s29, 73728
    buffer_load_dwordx4 v244, s[16:19], s31 offen offset:128 nt lds
    v_exp_f32 v34, v34
    v_fmamk_f32 v36, v36, 0x3dd53b95, v210
    v_xor_b32 v254, s6, v244
    s_add_u32 m0, s36, 0
    s_add_u32 s31, s30, s5
    s_add_u32 s31, s31, 0
    buffer_load_dwordx4 v254, s[12:15], s31 offen nt lds
    s_waitcnt lgkmcnt(2)
    v_mfma_f32_32x32x16_bf16 v[48:63], v[236:239], v[172:175], v[48:63]
    ds_read_b128 v[232:235], v247 offset:0
    s_add_u32 m0, s28, 89856
    s_add_u32 s31, s29, 73728
    buffer_load_dwordx4 v244, s[16:19], s31 offen offset:256 nt lds
    v_exp_f32 v35, v35
    v_fmamk_f32 v37, v37, 0x3dd53b95, v210
    v_exp_f32 v36, v36
    v_xor_b32 v254, s7, v244
    s_add_u32 m0, s36, 1024
    s_add_u32 s31, s30, s5
    s_add_u32 s31, s31, 3072
    buffer_load_dwordx4 v254, s[12:15], s31 offen nt lds
    s_waitcnt lgkmcnt(2)
    v_mfma_f32_32x32x16_bf16 v[64:79], v[224:227], v[128:131], 0
    ds_read_b128 v[236:239], v248 offset:0
    v_fmamk_f32 v38, v38, 0x3dd53b95, v210
    v_exp_f32 v37, v37
    v_fmamk_f32 v39, v39, 0x3dd53b95, v210
    v_xor_b32 v254, s6, v244
    s_add_u32 m0, s36, 2048
    s_add_u32 s31, s30, s5
    s_add_u32 s31, s31, 6144
    buffer_load_dwordx4 v254, s[12:15], s31 offen nt lds
    s_waitcnt lgkmcnt(2)
    v_mfma_f32_32x32x16_bf16 v[64:79], v[228:231], v[132:135], v[64:79]
    ds_read_b128 v[224:227], v245 offset:8192
    v_exp_f32 v38, v38
    v_fmamk_f32 v40, v40, 0x3dd53b95, v210
    v_xor_b32 v254, s7, v244
    s_add_u32 m0, s36, 3072
    s_add_u32 s31, s30, s5
    s_add_u32 s31, s31, 9216
    buffer_load_dwordx4 v254, s[12:15], s31 offen nt lds
    s_waitcnt lgkmcnt(2)
    v_mfma_f32_32x32x16_bf16 v[64:79], v[232:235], v[136:139], v[64:79]
    ds_read_b128 v[228:231], v246 offset:8192
    v_exp_f32 v39, v39
    v_fmamk_f32 v41, v41, 0x3dd53b95, v210
    v_exp_f32 v40, v40
    s_waitcnt lgkmcnt(2)
    v_mfma_f32_32x32x16_bf16 v[64:79], v[236:239], v[140:143], v[64:79]
    ds_read_b128 v[232:235], v247 offset:8192
    v_fmamk_f32 v42, v42, 0x3dd53b95, v210
    v_exp_f32 v41, v41
    v_fmamk_f32 v43, v43, 0x3dd53b95, v210
    s_waitcnt lgkmcnt(2)
    v_mfma_f32_32x32x16_bf16 v[64:79], v[224:227], v[144:147], v[64:79]
    ds_read_b128 v[236:239], v248 offset:8192
    v_max3_f32 v211, v48, v49, v50
    v_max3_f32 v211, v211, v51, v52
    v_max3_f32 v211, v211, v53, v54
    v_exp_f32 v42, v42
    v_fmamk_f32 v44, v44, 0x3dd53b95, v210
    s_waitcnt lgkmcnt(2)
    v_mfma_f32_32x32x16_bf16 v[64:79], v[228:231], v[148:151], v[64:79]
    ds_read_b128 v[224:227], v245 offset:16384
    v_max3_f32 v211, v211, v55, v56
    v_max3_f32 v211, v211, v57, v58
    v_exp_f32 v43, v43
    v_fmamk_f32 v45, v45, 0x3dd53b95, v210
    v_exp_f32 v44, v44
    s_waitcnt lgkmcnt(2)
    v_mfma_f32_32x32x16_bf16 v[64:79], v[232:235], v[152:155], v[64:79]
    ds_read_b128 v[228:231], v246 offset:16384
    v_max3_f32 v211, v211, v59, v60
    v_max3_f32 v211, v211, v61, v62
    v_fmamk_f32 v46, v46, 0x3dd53b95, v210
    v_exp_f32 v45, v45
    v_fmamk_f32 v47, v47, 0x3dd53b95, v210
    s_waitcnt lgkmcnt(2)
    v_mfma_f32_32x32x16_bf16 v[64:79], v[236:239], v[156:159], v[64:79]
    ds_read_b128 v[232:235], v247 offset:16384
    v_max_f32 v211, v211, v63
    v_mul_f32 v211, s32, v211
    v_exp_f32 v46, v46
    v_exp_f32 v47, v47
    s_waitcnt lgkmcnt(2)
    v_mfma_f32_32x32x16_bf16 v[64:79], v[224:227], v[160:163], v[64:79]
    ds_read_b128 v[236:239], v248 offset:16384
    v_fmamk_f32 v48, v48, 0x3dd53b95, v211
    v_fmamk_f32 v49, v49, 0x3dd53b95, v211
    v_exp_f32 v48, v48
    s_waitcnt lgkmcnt(2)
    v_mfma_f32_32x32x16_bf16 v[64:79], v[228:231], v[164:167], v[64:79]
    ds_read_b128 v[224:227], v245 offset:4096
    v_fmamk_f32 v50, v50, 0x3dd53b95, v211
    v_exp_f32 v49, v49
    v_fmamk_f32 v51, v51, 0x3dd53b95, v211
    s_waitcnt lgkmcnt(2)
    v_mfma_f32_32x32x16_bf16 v[64:79], v[232:235], v[168:171], v[64:79]
    ds_read_b128 v[228:231], v246 offset:4096
    v_exp_f32 v50, v50
    v_fmamk_f32 v52, v52, 0x3dd53b95, v211
    s_waitcnt lgkmcnt(2)
    v_mfma_f32_32x32x16_bf16 v[64:79], v[236:239], v[172:175], v[64:79]
    ds_read_b128 v[232:235], v247 offset:4096
    v_exp_f32 v51, v51
    v_fmamk_f32 v53, v53, 0x3dd53b95, v211
    v_exp_f32 v52, v52
    s_waitcnt lgkmcnt(2)
    v_mfma_f32_32x32x16_bf16 v[80:95], v[224:227], v[128:131], 0
    ds_read_b128 v[236:239], v248 offset:4096
    v_fmamk_f32 v54, v54, 0x3dd53b95, v211
    v_exp_f32 v53, v53
    v_fmamk_f32 v55, v55, 0x3dd53b95, v211
    s_waitcnt lgkmcnt(2)
    v_mfma_f32_32x32x16_bf16 v[80:95], v[228:231], v[132:135], v[80:95]
    ds_read_b128 v[224:227], v245 offset:12288
    v_exp_f32 v54, v54
    v_fmamk_f32 v56, v56, 0x3dd53b95, v211
    s_waitcnt lgkmcnt(2)
    v_mfma_f32_32x32x16_bf16 v[80:95], v[232:235], v[136:139], v[80:95]
    ds_read_b128 v[228:231], v246 offset:12288
    v_exp_f32 v55, v55
    v_fmamk_f32 v57, v57, 0x3dd53b95, v211
    v_exp_f32 v56, v56
    s_waitcnt lgkmcnt(2)
    v_mfma_f32_32x32x16_bf16 v[80:95], v[236:239], v[140:143], v[80:95]
    ds_read_b128 v[232:235], v247 offset:12288
    v_fmamk_f32 v58, v58, 0x3dd53b95, v211
    v_exp_f32 v57, v57
    v_fmamk_f32 v59, v59, 0x3dd53b95, v211
    s_waitcnt lgkmcnt(2)
    v_mfma_f32_32x32x16_bf16 v[80:95], v[224:227], v[144:147], v[80:95]
    ds_read_b128 v[236:239], v248 offset:12288
    v_max3_f32 v212, v64, v65, v66
    v_max3_f32 v212, v212, v67, v68
    v_max3_f32 v212, v212, v69, v70
    v_exp_f32 v58, v58
    v_fmamk_f32 v60, v60, 0x3dd53b95, v211
    s_waitcnt lgkmcnt(2)
    v_mfma_f32_32x32x16_bf16 v[80:95], v[228:231], v[148:151], v[80:95]
    ds_read_b128 v[224:227], v245 offset:20480
    v_max3_f32 v212, v212, v71, v72
    v_max3_f32 v212, v212, v73, v74
    v_exp_f32 v59, v59
    v_fmamk_f32 v61, v61, 0x3dd53b95, v211
    v_exp_f32 v60, v60
    s_waitcnt lgkmcnt(2)
    v_mfma_f32_32x32x16_bf16 v[80:95], v[232:235], v[152:155], v[80:95]
    ds_read_b128 v[228:231], v246 offset:20480
    v_max3_f32 v212, v212, v75, v76
    v_max3_f32 v212, v212, v77, v78
    v_fmamk_f32 v62, v62, 0x3dd53b95, v211
    v_exp_f32 v61, v61
    v_fmamk_f32 v63, v63, 0x3dd53b95, v211
    s_waitcnt lgkmcnt(2)
    v_mfma_f32_32x32x16_bf16 v[80:95], v[236:239], v[156:159], v[80:95]
    ds_read_b128 v[232:235], v247 offset:20480
    v_max_f32 v212, v212, v79
    v_mul_f32 v212, s32, v212
    v_exp_f32 v62, v62
    v_exp_f32 v63, v63
    s_waitcnt lgkmcnt(2)
    v_mfma_f32_32x32x16_bf16 v[80:95], v[224:227], v[160:163], v[80:95]
    ds_read_b128 v[236:239], v248 offset:20480
    v_fmamk_f32 v64, v64, 0x3dd53b95, v212
    v_fmamk_f32 v65, v65, 0x3dd53b95, v212
    v_exp_f32 v64, v64
    s_waitcnt lgkmcnt(2)
    v_mfma_f32_32x32x16_bf16 v[80:95], v[228:231], v[164:167], v[80:95]
    s_waitcnt vmcnt(3)
    s_barrier
    v_add_u32 v245, 73728, v249
    v_xor_b32 v246, 32, v245
    v_xor_b32 v247, 64, v245
    v_xor_b32 v248, 96, v245
    ds_read_b128 v[224:227], v245 offset:0
    s_add_u32 m0, s28, 0
    s_add_u32 s31, s29, 0
    buffer_load_dwordx4 v244, s[20:23], s31 offen offset:0 nt lds
    v_fmamk_f32 v66, v66, 0x3dd53b95, v212
    v_exp_f32 v65, v65
    v_fmamk_f32 v67, v67, 0x3dd53b95, v212
    s_waitcnt lgkmcnt(2)
    v_mfma_f32_32x32x16_bf16 v[80:95], v[232:235], v[168:171], v[80:95]
    ds_read_b128 v[228:231], v246 offset:0
    s_add_u32 m0, s28, 8064
    s_add_u32 s31, s29, 0
    buffer_load_dwordx4 v244, s[20:23], s31 offen offset:128 nt lds
    v_exp_f32 v66, v66
    v_fmamk_f32 v68, v68, 0x3dd53b95, v212
    s_waitcnt lgkmcnt(2)
    v_mfma_f32_32x32x16_bf16 v[80:95], v[236:239], v[172:175], v[80:95]
    ds_read_b128 v[232:235], v247 offset:0
    s_add_u32 m0, s28, 16128
    s_add_u32 s31, s29, 0
    buffer_load_dwordx4 v244, s[20:23], s31 offen offset:256 nt lds
    v_exp_f32 v67, v67
    v_fmamk_f32 v69, v69, 0x3dd53b95, v212
    v_exp_f32 v68, v68
    s_waitcnt lgkmcnt(2)
    v_mfma_f32_32x32x16_bf16 v[96:111], v[224:227], v[128:131], 0
    ds_read_b128 v[236:239], v248 offset:0
    v_fmamk_f32 v70, v70, 0x3dd53b95, v212
    v_exp_f32 v69, v69
    v_fmamk_f32 v71, v71, 0x3dd53b95, v212
    s_waitcnt lgkmcnt(2)
    v_mfma_f32_32x32x16_bf16 v[96:111], v[228:231], v[132:135], v[96:111]
    ds_read_b128 v[224:227], v245 offset:8192
    v_exp_f32 v70, v70
    v_fmamk_f32 v72, v72, 0x3dd53b95, v212
    s_waitcnt lgkmcnt(2)
    v_mfma_f32_32x32x16_bf16 v[96:111], v[232:235], v[136:139], v[96:111]
    ds_read_b128 v[228:231], v246 offset:8192
    v_exp_f32 v71, v71
    v_fmamk_f32 v73, v73, 0x3dd53b95, v212
    v_exp_f32 v72, v72
    s_waitcnt lgkmcnt(2)
    v_mfma_f32_32x32x16_bf16 v[96:111], v[236:239], v[140:143], v[96:111]
    ds_read_b128 v[232:235], v247 offset:8192
    v_fmamk_f32 v74, v74, 0x3dd53b95, v212
    v_exp_f32 v73, v73
    v_fmamk_f32 v75, v75, 0x3dd53b95, v212
    s_waitcnt lgkmcnt(2)
    v_mfma_f32_32x32x16_bf16 v[96:111], v[224:227], v[144:147], v[96:111]
    ds_read_b128 v[236:239], v248 offset:8192
    v_max3_f32 v213, v80, v81, v82
    v_max3_f32 v213, v213, v83, v84
    v_max3_f32 v213, v213, v85, v86
    v_exp_f32 v74, v74
    v_fmamk_f32 v76, v76, 0x3dd53b95, v212
    s_waitcnt lgkmcnt(2)
    v_mfma_f32_32x32x16_bf16 v[96:111], v[228:231], v[148:151], v[96:111]
    ds_read_b128 v[224:227], v245 offset:16384
    v_max3_f32 v213, v213, v87, v88
    v_max3_f32 v213, v213, v89, v90
    v_exp_f32 v75, v75
    v_fmamk_f32 v77, v77, 0x3dd53b95, v212
    v_exp_f32 v76, v76
    s_waitcnt lgkmcnt(2)
    v_mfma_f32_32x32x16_bf16 v[96:111], v[232:235], v[152:155], v[96:111]
    ds_read_b128 v[228:231], v246 offset:16384
    v_max3_f32 v213, v213, v91, v92
    v_max3_f32 v213, v213, v93, v94
    v_fmamk_f32 v78, v78, 0x3dd53b95, v212
    v_exp_f32 v77, v77
    v_fmamk_f32 v79, v79, 0x3dd53b95, v212
    s_waitcnt lgkmcnt(2)
    v_mfma_f32_32x32x16_bf16 v[96:111], v[236:239], v[156:159], v[96:111]
    ds_read_b128 v[232:235], v247 offset:16384
    v_max_f32 v213, v213, v95
    v_mul_f32 v213, s32, v213
    v_exp_f32 v78, v78
    v_exp_f32 v79, v79
    s_waitcnt lgkmcnt(2)
    v_mfma_f32_32x32x16_bf16 v[96:111], v[224:227], v[160:163], v[96:111]
    ds_read_b128 v[236:239], v248 offset:16384
    v_fmamk_f32 v80, v80, 0x3dd53b95, v213
    v_fmamk_f32 v81, v81, 0x3dd53b95, v213
    v_exp_f32 v80, v80
    s_waitcnt lgkmcnt(2)
    v_mfma_f32_32x32x16_bf16 v[96:111], v[228:231], v[164:167], v[96:111]
    ds_read_b128 v[224:227], v245 offset:4096
    v_fmamk_f32 v82, v82, 0x3dd53b95, v213
    v_exp_f32 v81, v81
    v_fmamk_f32 v83, v83, 0x3dd53b95, v213
    s_waitcnt lgkmcnt(2)
    v_mfma_f32_32x32x16_bf16 v[96:111], v[232:235], v[168:171], v[96:111]
    ds_read_b128 v[228:231], v246 offset:4096
    v_exp_f32 v82, v82
    v_fmamk_f32 v84, v84, 0x3dd53b95, v213
    s_waitcnt lgkmcnt(2)
    v_mfma_f32_32x32x16_bf16 v[96:111], v[236:239], v[172:175], v[96:111]
    ds_read_b128 v[232:235], v247 offset:4096
    v_exp_f32 v83, v83
    v_fmamk_f32 v85, v85, 0x3dd53b95, v213
    v_exp_f32 v84, v84
    s_waitcnt lgkmcnt(2)
    v_mfma_f32_32x32x16_bf16 v[112:127], v[224:227], v[128:131], 0
    ds_read_b128 v[236:239], v248 offset:4096
    v_fmamk_f32 v86, v86, 0x3dd53b95, v213
    v_exp_f32 v85, v85
    v_fmamk_f32 v87, v87, 0x3dd53b95, v213
    s_waitcnt lgkmcnt(2)
    v_mfma_f32_32x32x16_bf16 v[112:127], v[228:231], v[132:135], v[112:127]
    ds_read_b128 v[224:227], v245 offset:12288
    v_exp_f32 v86, v86
    v_fmamk_f32 v88, v88, 0x3dd53b95, v213
    s_waitcnt lgkmcnt(2)
    v_mfma_f32_32x32x16_bf16 v[112:127], v[232:235], v[136:139], v[112:127]
    ds_read_b128 v[228:231], v246 offset:12288
    v_exp_f32 v87, v87
    v_fmamk_f32 v89, v89, 0x3dd53b95, v213
    v_exp_f32 v88, v88
    s_waitcnt lgkmcnt(2)
    v_mfma_f32_32x32x16_bf16 v[112:127], v[236:239], v[140:143], v[112:127]
    ds_read_b128 v[232:235], v247 offset:12288
    v_fmamk_f32 v90, v90, 0x3dd53b95, v213
    v_exp_f32 v89, v89
    v_fmamk_f32 v91, v91, 0x3dd53b95, v213
    s_waitcnt lgkmcnt(2)
    v_mfma_f32_32x32x16_bf16 v[112:127], v[224:227], v[144:147], v[112:127]
    ds_read_b128 v[236:239], v248 offset:12288
    v_max3_f32 v214, v96, v97, v98
    v_max3_f32 v214, v214, v99, v100
    v_max3_f32 v214, v214, v101, v102
    v_exp_f32 v90, v90
    v_fmamk_f32 v92, v92, 0x3dd53b95, v213
    s_waitcnt lgkmcnt(2)
    v_mfma_f32_32x32x16_bf16 v[112:127], v[228:231], v[148:151], v[112:127]
    ds_read_b128 v[224:227], v245 offset:20480
    v_max3_f32 v214, v214, v103, v104
    v_max3_f32 v214, v214, v105, v106
    v_exp_f32 v91, v91
    v_fmamk_f32 v93, v93, 0x3dd53b95, v213
    v_exp_f32 v92, v92
    s_waitcnt lgkmcnt(2)
    v_mfma_f32_32x32x16_bf16 v[112:127], v[232:235], v[152:155], v[112:127]
    ds_read_b128 v[228:231], v246 offset:20480
    v_max3_f32 v214, v214, v107, v108
    v_max3_f32 v214, v214, v109, v110
    v_fmamk_f32 v94, v94, 0x3dd53b95, v213
    v_exp_f32 v93, v93
    v_fmamk_f32 v95, v95, 0x3dd53b95, v213
    s_waitcnt lgkmcnt(2)
    v_mfma_f32_32x32x16_bf16 v[112:127], v[236:239], v[156:159], v[112:127]
    ds_read_b128 v[232:235], v247 offset:20480
    v_max_f32 v214, v214, v111
    v_mul_f32 v214, s32, v214
    v_exp_f32 v94, v94
    v_exp_f32 v95, v95
    s_waitcnt lgkmcnt(2)
    v_mfma_f32_32x32x16_bf16 v[112:127], v[224:227], v[160:163], v[112:127]
    ds_read_b128 v[236:239], v248 offset:20480
    s_waitcnt lgkmcnt(2)
    v_mfma_f32_32x32x16_bf16 v[112:127], v[228:231], v[164:167], v[112:127]
    s_waitcnt vmcnt(0)
    s_barrier
    v_add_u32 v245, 0, v251
    v_xor_b32 v246, 16, v245
    v_xor_b32 v247, 64, v245
    v_xor_b32 v248, 0x50, v245
    ds_read_b64_tr_b16 v[224:225], v245 offset:0
    ds_read_b64_tr_b16 v[226:227], v246 offset:1024
    s_add_u32 m0, s28, 24576
    s_add_u32 s31, s29, 24576
    buffer_load_dwordx4 v244, s[20:23], s31 offen offset:0 nt lds
    s_waitcnt lgkmcnt(3)
    v_mfma_f32_32x32x16_bf16 v[112:127], v[232:235], v[168:171], v[112:127]
    ds_read_b64_tr_b16 v[228:229], v247 offset:0
    ds_read_b64_tr_b16 v[230:231], v248 offset:1024
    s_add_u32 m0, s28, 32640
    s_add_u32 s31, s29, 24576
    buffer_load_dwordx4 v244, s[20:23], s31 offen offset:128 nt lds
    s_waitcnt lgkmcnt(4)
    v_mfma_f32_32x32x16_bf16 v[112:127], v[236:239], v[172:175], v[112:127]
    ds_read_b64_tr_b16 v[232:233], v245 offset:8192
    ds_read_b64_tr_b16 v[234:235], v246 offset:9216
    s_add_u32 m0, s28, 40704
    s_add_u32 s31, s29, 24576
    buffer_load_dwordx4 v244, s[20:23], s31 offen offset:256 nt lds
    s_nop 7
    s_nop 3
    v_max3_f32 v215, v112, v113, v114
    v_max3_f32 v215, v215, v115, v116
    v_max3_f32 v215, v215, v117, v118
    v_max3_f32 v215, v215, v119, v120
    v_max3_f32 v215, v215, v121, v122
    v_max3_f32 v215, v215, v123, v124
    v_max3_f32 v215, v215, v125, v126
    v_max_f32 v215, v215, v127
    v_mul_f32 v215, s32, v215
    v_min3_f32 v250, v208, v209, v210
    v_min3_f32 v250, v250, v211, v212
    v_min3_f32 v250, v250, v213, v214
    v_min_f32 v250, v250, v215
    v_mov_b32 v254, v250
    s_nop 1
    v_permlane32_swap_b32 v250, v254
    s_nop 1
    v_min_f32 v250, v250, v254
    v_sub_f32 v254, v250, v208
    v_exp_f32 v254, v254
    v_sub_f32 v213, v250, v213
    v_mul_f32 v0, v254, v0
    v_mul_f32 v1, v254, v1
    v_mul_f32 v2, v254, v2
    v_mul_f32 v3, v254, v3
    v_mul_f32 v4, v254, v4
    v_mul_f32 v5, v254, v5
    v_mul_f32 v6, v254, v6
    v_mul_f32 v7, v254, v7
    v_mov_b32 v252, v0
    v_mov_b32 v253, v1
    v_cvt_pk_bf16_f32 v0, v0, v1
    v_add_f32 v252, v252, v2
    v_add_f32 v253, v253, v3
    v_cvt_pk_bf16_f32 v1, v2, v3
    v_add_f32 v252, v252, v4
    v_add_f32 v253, v253, v5
    v_cvt_pk_bf16_f32 v2, v4, v5
    v_add_f32 v252, v252, v6
    v_add_f32 v253, v253, v7
    v_cvt_pk_bf16_f32 v3, v6, v7
    v_exp_f32 v255, v213
    v_sub_f32 v4, v250, v209
    v_sub_f32 v5, v250, v210
    v_sub_f32 v6, v250, v211
    v_sub_f32 v7, v250, v212
    v_exp_f32 v4, v4
    v_exp_f32 v5, v5
    v_exp_f32 v6, v6
    v_exp_f32 v7, v7
    s_nop 0
    s_waitcnt lgkmcnt(4)
    v_mfma_f32_32x32x16_bf16 v[128:143], v[224:227], v[0:3], 0
    ds_read_b64_tr_b16 v[236:237], v247 offset:8192
    ds_read_b64_tr_b16 v[238:239], v248 offset:9216
    v_mul_f32 v8, v254, v8
    v_mul_f32 v9, v254, v9
    v_mul_f32 v10, v254, v10
    v_mul_f32 v11, v254, v11
    v_fmamk_f32 v96, v96, 0x3dd53b95, v250
    s_waitcnt lgkmcnt(4)
    v_mfma_f32_32x32x16_bf16 v[144:159], v[228:231], v[0:3], 0
    ds_read_b64_tr_b16 v[224:225], v245 offset:16384
    ds_read_b64_tr_b16 v[226:227], v246 offset:17408
    v_mul_f32 v12, v254, v12
    v_mul_f32 v13, v254, v13
    v_mul_f32 v14, v254, v14
    v_mul_f32 v15, v254, v15
    v_fmamk_f32 v97, v97, 0x3dd53b95, v250
    s_waitcnt lgkmcnt(4)
    v_mfma_f32_32x32x16_bf16 v[160:175], v[232:235], v[0:3], 0
    ds_read_b64_tr_b16 v[228:229], v247 offset:16384
    ds_read_b64_tr_b16 v[230:231], v248 offset:17408
    v_add_f32 v252, v252, v8
    v_add_f32 v253, v253, v9
    v_cvt_pk_bf16_f32 v8, v8, v9
    v_add_f32 v252, v252, v10
    s_waitcnt lgkmcnt(4)
    v_mfma_f32_32x32x16_bf16 v[176:191], v[236:239], v[0:3], 0
    ds_read_b64_tr_b16 v[232:233], v245 offset:2048
    ds_read_b64_tr_b16 v[234:235], v246 offset:3072
    v_add_f32 v253, v253, v11
    v_cvt_pk_bf16_f32 v9, v10, v11
    v_add_f32 v252, v252, v12
    v_add_f32 v253, v253, v13
    v_exp_f32 v96, v96
    s_waitcnt lgkmcnt(4)
    v_mfma_f32_32x32x16_bf16 v[192:207], v[224:227], v[0:3], 0
    ds_read_b64_tr_b16 v[236:237], v247 offset:2048
    ds_read_b64_tr_b16 v[238:239], v248 offset:3072
    v_cvt_pk_bf16_f32 v10, v12, v13
    v_add_f32 v252, v252, v14
    v_add_f32 v253, v253, v15
    v_cvt_pk_bf16_f32 v11, v14, v15
    s_waitcnt lgkmcnt(4)
    v_mfma_f32_32x32x16_bf16 v[208:223], v[228:231], v[0:3], 0
    ds_read_b64_tr_b16 v[224:225], v245 offset:10240
    ds_read_b64_tr_b16 v[226:227], v246 offset:11264
    v_fmamk_f32 v98, v98, 0x3dd53b95, v250
    s_waitcnt lgkmcnt(4)
    v_mfma_f32_32x32x16_bf16 v[128:143], v[232:235], v[8:11], v[128:143]
    ds_read_b64_tr_b16 v[228:229], v247 offset:10240
    ds_read_b64_tr_b16 v[230:231], v248 offset:11264
    v_mul_f32 v16, v4, v16
    v_mul_f32 v17, v4, v17
    v_mul_f32 v18, v4, v18
    v_mul_f32 v19, v4, v19
    v_fmamk_f32 v112, v112, 0x3dd53b95, v250
    s_waitcnt lgkmcnt(4)
    v_mfma_f32_32x32x16_bf16 v[144:159], v[236:239], v[8:11], v[144:159]
    ds_read_b64_tr_b16 v[232:233], v245 offset:18432
    ds_read_b64_tr_b16 v[234:235], v246 offset:19456
    v_mul_f32 v20, v4, v20
    v_mul_f32 v21, v4, v21
    v_mul_f32 v22, v4, v22
    v_mul_f32 v23, v4, v23
    v_exp_f32 v97, v97
    v_fmamk_f32 v113, v113, 0x3dd53b95, v250
    s_waitcnt lgkmcnt(4)
    v_mfma_f32_32x32x16_bf16 v[160:175], v[224:227], v[8:11], v[160:175]
    ds_read_b64_tr_b16 v[236:237], v247 offset:18432
    ds_read_b64_tr_b16 v[238:239], v248 offset:19456
    v_add_f32 v252, v252, v16
    v_add_f32 v253, v253, v17
    v_cvt_pk_bf16_f32 v16, v16, v17
    v_add_f32 v252, v252, v18
    s_waitcnt lgkmcnt(4)
    v_mfma_f32_32x32x16_bf16 v[176:191], v[228:231], v[8:11], v[176:191]
    ds_read_b64_tr_b16 v[224:225], v245 offset:4096
    ds_read_b64_tr_b16 v[226:227], v246 offset:5120
    v_add_f32 v253, v253, v19
    v_cvt_pk_bf16_f32 v17, v18, v19
    v_add_f32 v252, v252, v20
    v_add_f32 v253, v253, v21
    v_fmamk_f32 v99, v99, 0x3dd53b95, v250
    v_exp_f32 v112, v112
    s_waitcnt lgkmcnt(4)
    v_mfma_f32_32x32x16_bf16 v[192:207], v[232:235], v[8:11], v[192:207]
    ds_read_b64_tr_b16 v[228:229], v247 offset:4096
    ds_read_b64_tr_b16 v[230:231], v248 offset:5120
    v_cvt_pk_bf16_f32 v18, v20, v21
    v_add_f32 v252, v252, v22
    v_add_f32 v253, v253, v23
    v_cvt_pk_bf16_f32 v19, v22, v23
    v_exp_f32 v98, v98
    s_waitcnt lgkmcnt(4)
    v_mfma_f32_32x32x16_bf16 v[208:223], v[236:239], v[8:11], v[208:223]
    ds_read_b64_tr_b16 v[232:233], v245 offset:12288
    ds_read_b64_tr_b16 v[234:235], v246 offset:13312
    v_fmamk_f32 v114, v114, 0x3dd53b95, v250
    s_waitcnt lgkmcnt(4)
    v_mfma_f32_32x32x16_bf16 v[128:143], v[224:227], v[16:19], v[128:143]
    ds_read_b64_tr_b16 v[236:237], v247 offset:12288
    ds_read_b64_tr_b16 v[238:239], v248 offset:13312
    v_mul_f32 v24, v4, v24
    v_mul_f32 v25, v4, v25
    v_mul_f32 v26, v4, v26
    v_mul_f32 v27, v4, v27
    v_fmamk_f32 v100, v100, 0x3dd53b95, v250
    s_waitcnt lgkmcnt(4)
    v_mfma_f32_32x32x16_bf16 v[144:159], v[228:231], v[16:19], v[144:159]
    ds_read_b64_tr_b16 v[224:225], v245 offset:20480
    ds_read_b64_tr_b16 v[226:227], v246 offset:21504
    v_mul_f32 v28, v4, v28
    v_mul_f32 v29, v4, v29
    v_mul_f32 v30, v4, v30
    v_mul_f32 v31, v4, v31
    v_exp_f32 v113, v113
    s_waitcnt lgkmcnt(4)
    v_mfma_f32_32x32x16_bf16 v[160:175], v[232:235], v[16:19], v[160:175]
    ds_read_b64_tr_b16 v[228:229], v247 offset:20480
    ds_read_b64_tr_b16 v[230:231], v248 offset:21504
    v_add_f32 v252, v252, v24
    v_add_f32 v253, v253, v25
    v_cvt_pk_bf16_f32 v24, v24, v25
    v_add_f32 v252, v252, v26
    v_exp_f32 v99, v99
    s_waitcnt lgkmcnt(4)
    v_mfma_f32_32x32x16_bf16 v[176:191], v[236:239], v[16:19], v[176:191]
    ds_read_b64_tr_b16 v[232:233], v245 offset:6144
    ds_read_b64_tr_b16 v[234:235], v246 offset:7168
    v_add_f32 v253, v253, v27
    v_cvt_pk_bf16_f32 v25, v26, v27
    v_add_f32 v252, v252, v28
    v_add_f32 v253, v253, v29
    v_fmamk_f32 v115, v115, 0x3dd53b95, v250
    s_waitcnt lgkmcnt(4)
    v_mfma_f32_32x32x16_bf16 v[192:207], v[224:227], v[16:19], v[192:207]
    ds_read_b64_tr_b16 v[236:237], v247 offset:6144
    ds_read_b64_tr_b16 v[238:239], v248 offset:7168
    v_cvt_pk_bf16_f32 v26, v28, v29
    v_add_f32 v252, v252, v30
    v_add_f32 v253, v253, v31
    v_cvt_pk_bf16_f32 v27, v30, v31
    v_fmamk_f32 v101, v101, 0x3dd53b95, v250
    v_exp_f32 v114, v114
    s_waitcnt lgkmcnt(4)
    v_mfma_f32_32x32x16_bf16 v[208:223], v[228:231], v[16:19], v[208:223]
    ds_read_b64_tr_b16 v[224:225], v245 offset:14336
    ds_read_b64_tr_b16 v[226:227], v246 offset:15360
    s_waitcnt lgkmcnt(4)
    v_mfma_f32_32x32x16_bf16 v[128:143], v[232:235], v[24:27], v[128:143]
    ds_read_b64_tr_b16 v[228:229], v247 offset:14336
    ds_read_b64_tr_b16 v[230:231], v248 offset:15360
    v_mul_f32 v32, v5, v32
    v_mul_f32 v33, v5, v33
    v_mul_f32 v34, v5, v34
    v_mul_f32 v35, v5, v35
    v_exp_f32 v100, v100
    v_fmamk_f32 v116, v116, 0x3dd53b95, v250
    s_waitcnt lgkmcnt(4)
    v_mfma_f32_32x32x16_bf16 v[144:159], v[236:239], v[24:27], v[144:159]
    ds_read_b64_tr_b16 v[232:233], v245 offset:22528
    ds_read_b64_tr_b16 v[234:235], v246 offset:23552
    v_mul_f32 v36, v5, v36
    v_mul_f32 v37, v5, v37
    v_mul_f32 v38, v5, v38
    v_mul_f32 v39, v5, v39
    v_fmamk_f32 v102, v102, 0x3dd53b95, v250
    s_waitcnt lgkmcnt(4)
    v_mfma_f32_32x32x16_bf16 v[160:175], v[224:227], v[24:27], v[160:175]
    ds_read_b64_tr_b16 v[236:237], v247 offset:22528
    ds_read_b64_tr_b16 v[238:239], v248 offset:23552
    v_add_f32 v252, v252, v32
    v_add_f32 v253, v253, v33
    v_cvt_pk_bf16_f32 v32, v32, v33
    v_add_f32 v252, v252, v34
    v_exp_f32 v115, v115
    s_waitcnt lgkmcnt(4)
    v_mfma_f32_32x32x16_bf16 v[176:191], v[228:231], v[24:27], v[176:191]
    s_waitcnt vmcnt(0)
    s_barrier
    v_add_u32 v245, 24576, v251
    v_xor_b32 v246, 16, v245
    v_xor_b32 v247, 64, v245
    v_xor_b32 v248, 0x50, v245
    ds_read_b64_tr_b16 v[224:225], v245 offset:0
    ds_read_b64_tr_b16 v[226:227], v246 offset:1024
    s_add_u32 m0, s28, 49152
    s_add_u32 s31, s29, 49152
    buffer_load_dwordx4 v244, s[20:23], s31 offen offset:0 nt lds
    v_add_f32 v253, v253, v35
    v_cvt_pk_bf16_f32 v33, v34, v35
    v_add_f32 v252, v252, v36
    v_add_f32 v253, v253, v37
    v_exp_f32 v101, v101
    s_waitcnt lgkmcnt(4)
    v_mfma_f32_32x32x16_bf16 v[192:207], v[232:235], v[24:27], v[192:207]
    ds_read_b64_tr_b16 v[228:229], v247 offset:0
    ds_read_b64_tr_b16 v[230:231], v248 offset:1024
    s_add_u32 m0, s28, 57216
    s_add_u32 s31, s29, 49152
    buffer_load_dwordx4 v244, s[20:23], s31 offen offset:128 nt lds
    v_cvt_pk_bf16_f32 v34, v36, v37
    v_add_f32 v252, v252, v38
    v_add_f32 v253, v253, v39
    v_cvt_pk_bf16_f32 v35, v38, v39
    v_fmamk_f32 v117, v117, 0x3dd53b95, v250
    s_waitcnt lgkmcnt(4)
    v_mfma_f32_32x32x16_bf16 v[208:223], v[236:239], v[24:27], v[208:223]
    ds_read_b64_tr_b16 v[232:233], v245 offset:8192
    ds_read_b64_tr_b16 v[234:235], v246 offset:9216
    s_add_u32 m0, s28, 65280
    s_add_u32 s31, s29, 49152
    buffer_load_dwordx4 v244, s[20:23], s31 offen offset:256 nt lds
    v_fmamk_f32 v103, v103, 0x3dd53b95, v250
    s_waitcnt lgkmcnt(4)
    v_mfma_f32_32x32x16_bf16 v[128:143], v[224:227], v[32:35], v[128:143]
    ds_read_b64_tr_b16 v[236:237], v247 offset:8192
    ds_read_b64_tr_b16 v[238:239], v248 offset:9216
    v_mul_f32 v40, v5, v40
    v_mul_f32 v41, v5, v41
    v_mul_f32 v42, v5, v42
    v_mul_f32 v43, v5, v43
    v_exp_f32 v116, v116
    s_waitcnt vmcnt(9)
    v_add_u32 v0, s36, v249
    v_xor_b32 v1, 32, v0
    v_xor_b32 v2, 64, v0
    v_xor_b32 v3, 96, v0
    ds_read_b128 v[16:19], v0
    ds_read_b128 v[20:23], v1
    ds_read_b128 v[24:27], v2
    ds_read_b128 v[28:31], v3
    s_waitcnt lgkmcnt(8)
    v_mfma_f32_32x32x16_bf16 v[144:159], v[228:231], v[32:35], v[144:159]
    ds_read_b64_tr_b16 v[224:225], v245 offset:16384
    ds_read_b64_tr_b16 v[226:227], v246 offset:17408
    v_mul_f32 v44, v5, v44
    v_mul_f32 v45, v5, v45
    v_mul_f32 v46, v5, v46
    v_mul_f32 v47, v5, v47
    v_exp_f32 v102, v102
    v_fmamk_f32 v118, v118, 0x3dd53b95, v250
    s_waitcnt lgkmcnt(8)
    v_mfma_f32_32x32x16_bf16 v[160:175], v[232:235], v[32:35], v[160:175]
    ds_read_b64_tr_b16 v[228:229], v247 offset:16384
    ds_read_b64_tr_b16 v[230:231], v248 offset:17408
    v_add_f32 v252, v252, v40
    v_add_f32 v253, v253, v41
    v_cvt_pk_bf16_f32 v40, v40, v41
    v_add_f32 v252, v252, v42
    s_waitcnt lgkmcnt(8)
    v_mfma_f32_32x32x16_bf16 v[176:191], v[236:239], v[32:35], v[176:191]
    ds_read_b64_tr_b16 v[232:233], v245 offset:2048
    ds_read_b64_tr_b16 v[234:235], v246 offset:3072
    v_add_f32 v253, v253, v43
    v_cvt_pk_bf16_f32 v41, v42, v43
    v_add_f32 v252, v252, v44
    v_add_f32 v253, v253, v45
    v_fmamk_f32 v104, v104, 0x3dd53b95, v250
    v_exp_f32 v117, v117
    s_waitcnt lgkmcnt(4)
    v_mfma_f32_32x32x16_bf16 v[192:207], v[224:227], v[32:35], v[192:207]
    ds_read_b64_tr_b16 v[236:237], v247 offset:2048
    ds_read_b64_tr_b16 v[238:239], v248 offset:3072
    v_cvt_pk_bf16_f32 v42, v44, v45
    v_add_f32 v252, v252, v46
    v_add_f32 v253, v253, v47
    v_cvt_pk_bf16_f32 v43, v46, v47
    s_waitcnt lgkmcnt(4)
    v_mfma_f32_32x32x16_bf16 v[208:223], v[228:231], v[32:35], v[208:223]
    ds_read_b64_tr_b16 v[224:225], v245 offset:10240
    ds_read_b64_tr_b16 v[226:227], v246 offset:11264
    v_exp_f32 v103, v103
    v_fmamk_f32 v119, v119, 0x3dd53b95, v250
    s_waitcnt lgkmcnt(10)
    v_xor_b32 v254, s6, v244
    s_add_u32 m0, s36, 0
    s_add_u32 s31, s30, s5
    s_add_u32 s31, s31, 256
    buffer_load_dwordx4 v254, s[12:15], s31 offen nt lds
    s_waitcnt lgkmcnt(4)
    v_mfma_f32_32x32x16_bf16 v[128:143], v[232:235], v[40:43], v[128:143]
    ds_read_b64_tr_b16 v[228:229], v247 offset:10240
    ds_read_b64_tr_b16 v[230:231], v248 offset:11264
    v_mul_f32 v48, v6, v48
    v_mul_f32 v49, v6, v49
    v_mul_f32 v50, v6, v50
    v_mul_f32 v51, v6, v51
    v_fmamk_f32 v105, v105, 0x3dd53b95, v250
    s_waitcnt lgkmcnt(4)
    v_mfma_f32_32x32x16_bf16 v[144:159], v[236:239], v[40:43], v[144:159]
    ds_read_b64_tr_b16 v[232:233], v245 offset:18432
    ds_read_b64_tr_b16 v[234:235], v246 offset:19456
    v_mul_f32 v52, v6, v52
    v_mul_f32 v53, v6, v53
    v_mul_f32 v54, v6, v54
    v_mul_f32 v55, v6, v55
    v_exp_f32 v118, v118
    s_waitcnt lgkmcnt(4)
    v_mfma_f32_32x32x16_bf16 v[160:175], v[224:227], v[40:43], v[160:175]
    ds_read_b64_tr_b16 v[236:237], v247 offset:18432
    ds_read_b64_tr_b16 v[238:239], v248 offset:19456
    v_add_f32 v252, v252, v48
    v_add_f32 v253, v253, v49
    v_cvt_pk_bf16_f32 v48, v48, v49
    v_add_f32 v252, v252, v50
    v_exp_f32 v104, v104
    s_waitcnt lgkmcnt(4)
    v_mfma_f32_32x32x16_bf16 v[176:191], v[228:231], v[40:43], v[176:191]
    ds_read_b64_tr_b16 v[224:225], v245 offset:4096
    ds_read_b64_tr_b16 v[226:227], v246 offset:5120
    v_add_f32 v253, v253, v51
    v_cvt_pk_bf16_f32 v49, v50, v51
    v_add_f32 v252, v252, v52
    v_add_f32 v253, v253, v53
    v_fmamk_f32 v120, v120, 0x3dd53b95, v250
    s_waitcnt lgkmcnt(4)
    v_mfma_f32_32x32x16_bf16 v[192:207], v[232:235], v[40:43], v[192:207]
    ds_read_b64_tr_b16 v[228:229], v247 offset:4096
    ds_read_b64_tr_b16 v[230:231], v248 offset:5120
    v_cvt_pk_bf16_f32 v50, v52, v53
    v_add_f32 v252, v252, v54
    v_add_f32 v253, v253, v55
    v_cvt_pk_bf16_f32 v51, v54, v55
    v_fmamk_f32 v106, v106, 0x3dd53b95, v250
    s_waitcnt lgkmcnt(4)
    v_mfma_f32_32x32x16_bf16 v[208:223], v[236:239], v[40:43], v[208:223]
    ds_read_b64_tr_b16 v[232:233], v245 offset:12288
    ds_read_b64_tr_b16 v[234:235], v246 offset:13312
    v_exp_f32 v119, v119
    s_waitcnt lgkmcnt(4)
    v_mfma_f32_32x32x16_bf16 v[128:143], v[224:227], v[48:51], v[128:143]
    ds_read_b64_tr_b16 v[236:237], v247 offset:12288
    ds_read_b64_tr_b16 v[238:239], v248 offset:13312
    v_mul_f32 v56, v6, v56
    v_mul_f32 v57, v6, v57
    v_mul_f32 v58, v6, v58
    v_mul_f32 v59, v6, v59
    v_exp_f32 v105, v105
    v_fmamk_f32 v121, v121, 0x3dd53b95, v250
    s_waitcnt vmcnt(17)
    v_add_u32 v0, s4, v249
    v_xor_b32 v1, 32, v0
    v_xor_b32 v2, 64, v0
    v_xor_b32 v3, 96, v0
    ds_read_b128 v[32:35], v0
    ds_read_b128 v[36:39], v1
    ds_read_b128 v[40:43], v2
    ds_read_b128 v[44:47], v3
    s_waitcnt lgkmcnt(8)
    v_mfma_f32_32x32x16_bf16 v[144:159], v[228:231], v[48:51], v[144:159]
    ds_read_b64_tr_b16 v[224:225], v245 offset:20480
    ds_read_b64_tr_b16 v[226:227], v246 offset:21504
    v_mul_f32 v60, v6, v60
    v_mul_f32 v61, v6, v61
    v_mul_f32 v62, v6, v62
    v_mul_f32 v63, v6, v63
    v_xor_b32 v254, s7, v244
    s_add_u32 m0, s36, 1024
    s_add_u32 s31, s30, s5
    s_add_u32 s31, s31, 3328
    buffer_load_dwordx4 v254, s[12:15], s31 offen nt lds
    s_waitcnt lgkmcnt(8)
    v_mfma_f32_32x32x16_bf16 v[160:175], v[232:235], v[48:51], v[160:175]
    ds_read_b64_tr_b16 v[228:229], v247 offset:20480
    ds_read_b64_tr_b16 v[230:231], v248 offset:21504
    v_add_f32 v252, v252, v56
    v_add_f32 v253, v253, v57
    v_cvt_pk_bf16_f32 v56, v56, v57
    v_add_f32 v252, v252, v58
    v_fmamk_f32 v107, v107, 0x3dd53b95, v250
    v_exp_f32 v120, v120
    s_waitcnt lgkmcnt(8)
    v_mfma_f32_32x32x16_bf16 v[176:191], v[236:239], v[48:51], v[176:191]
    ds_read_b64_tr_b16 v[232:233], v245 offset:6144
    ds_read_b64_tr_b16 v[234:235], v246 offset:7168
    v_add_f32 v253, v253, v59
    v_cvt_pk_bf16_f32 v57, v58, v59
    v_add_f32 v252, v252, v60
    v_add_f32 v253, v253, v61
    v_exp_f32 v106, v106
    s_waitcnt lgkmcnt(4)
    v_mfma_f32_32x32x16_bf16 v[192:207], v[224:227], v[48:51], v[192:207]
    ds_read_b64_tr_b16 v[236:237], v247 offset:6144
    ds_read_b64_tr_b16 v[238:239], v248 offset:7168
    v_cvt_pk_bf16_f32 v58, v60, v61
    v_add_f32 v252, v252, v62
    v_add_f32 v253, v253, v63
    v_cvt_pk_bf16_f32 v59, v62, v63
    v_fmamk_f32 v122, v122, 0x3dd53b95, v250
    s_waitcnt lgkmcnt(4)
    v_mfma_f32_32x32x16_bf16 v[208:223], v[228:231], v[48:51], v[208:223]
    ds_read_b64_tr_b16 v[224:225], v245 offset:14336
    ds_read_b64_tr_b16 v[226:227], v246 offset:15360
    v_fmamk_f32 v108, v108, 0x3dd53b95, v250
    s_waitcnt lgkmcnt(4)
    v_mfma_f32_32x32x16_bf16 v[128:143], v[232:235], v[56:59], v[128:143]
    ds_read_b64_tr_b16 v[228:229], v247 offset:14336
    ds_read_b64_tr_b16 v[230:231], v248 offset:15360
    v_mul_f32 v64, v7, v64
    v_mul_f32 v65, v7, v65
    v_mul_f32 v66, v7, v66
    v_mul_f32 v67, v7, v67
    v_exp_f32 v121, v121
    s_waitcnt lgkmcnt(4)
    v_mfma_f32_32x32x16_bf16 v[144:159], v[236:239], v[56:59], v[144:159]
    ds_read_b64_tr_b16 v[232:233], v245 offset:22528
    ds_read_b64_tr_b16 v[234:235], v246 offset:23552
    v_mul_f32 v68, v7, v68
    v_mul_f32 v69, v7, v69
    v_mul_f32 v70, v7, v70
    v_mul_f32 v71, v7, v71
    v_exp_f32 v107, v107
    s_waitcnt lgkmcnt(4)
    v_mfma_f32_32x32x16_bf16 v[160:175], v[224:227], v[56:59], v[160:175]
    ds_read_b64_tr_b16 v[236:237], v247 offset:22528
    ds_read_b64_tr_b16 v[238:239], v248 offset:23552
    v_add_f32 v252, v252, v64
    v_add_f32 v253, v253, v65
    v_cvt_pk_bf16_f32 v64, v64, v65
    v_add_f32 v252, v252, v66
    v_fmamk_f32 v123, v123, 0x3dd53b95, v250
    s_waitcnt lgkmcnt(4)
    v_mfma_f32_32x32x16_bf16 v[176:191], v[228:231], v[56:59], v[176:191]
    s_waitcnt vmcnt(2)
    s_barrier
    v_add_u32 v245, 49152, v251
    v_xor_b32 v246, 16, v245
    v_xor_b32 v247, 64, v245
    v_xor_b32 v248, 0x50, v245
    ds_read_b64_tr_b16 v[224:225], v245 offset:0
    ds_read_b64_tr_b16 v[226:227], v246 offset:1024
    s_add_u32 m0, s28, 73728
    s_add_u32 s31, s29, 73728
    buffer_load_dwordx4 v244, s[20:23], s31 offen offset:0 nt lds
    v_add_f32 v253, v253, v67
    v_cvt_pk_bf16_f32 v65, v66, v67
    v_add_f32 v252, v252, v68
    v_add_f32 v253, v253, v69
    v_fmamk_f32 v109, v109, 0x3dd53b95, v250
    v_exp_f32 v122, v122
    v_xor_b32 v254, s6, v244
    s_add_u32 m0, s36, 2048
    s_add_u32 s31, s30, s5
    s_add_u32 s31, s31, 6400
    buffer_load_dwordx4 v254, s[12:15], s31 offen nt lds
    s_waitcnt lgkmcnt(4)
    v_mfma_f32_32x32x16_bf16 v[192:207], v[232:235], v[56:59], v[192:207]
    ds_read_b64_tr_b16 v[228:229], v247 offset:0
    ds_read_b64_tr_b16 v[230:231], v248 offset:1024
    s_add_u32 m0, s28, 81792
    s_add_u32 s31, s29, 73728
    buffer_load_dwordx4 v244, s[20:23], s31 offen offset:128 nt lds
    v_cvt_pk_bf16_f32 v66, v68, v69
    v_add_f32 v252, v252, v70
    v_add_f32 v253, v253, v71
    v_cvt_pk_bf16_f32 v67, v70, v71
    s_waitcnt lgkmcnt(4)
    v_mfma_f32_32x32x16_bf16 v[208:223], v[236:239], v[56:59], v[208:223]
    ds_read_b64_tr_b16 v[232:233], v245 offset:8192
    ds_read_b64_tr_b16 v[234:235], v246 offset:9216
    s_add_u32 m0, s28, 89856
    s_add_u32 s31, s29, 73728
    buffer_load_dwordx4 v244, s[20:23], s31 offen offset:256 nt lds
    v_exp_f32 v108, v108
    v_fmamk_f32 v124, v124, 0x3dd53b95, v250
    s_waitcnt lgkmcnt(4)
    v_mfma_f32_32x32x16_bf16 v[128:143], v[224:227], v[64:67], v[128:143]
    ds_read_b64_tr_b16 v[236:237], v247 offset:8192
    ds_read_b64_tr_b16 v[238:239], v248 offset:9216
    v_mul_f32 v72, v7, v72
    v_mul_f32 v73, v7, v73
    v_mul_f32 v74, v7, v74
    v_mul_f32 v75, v7, v75
    v_fmamk_f32 v110, v110, 0x3dd53b95, v250
    s_waitcnt lgkmcnt(4)
    v_mfma_f32_32x32x16_bf16 v[144:159], v[228:231], v[64:67], v[144:159]
    ds_read_b64_tr_b16 v[224:225], v245 offset:16384
    ds_read_b64_tr_b16 v[226:227], v246 offset:17408
    v_mul_f32 v76, v7, v76
    v_mul_f32 v77, v7, v77
    v_mul_f32 v78, v7, v78
    v_mul_f32 v79, v7, v79
    v_exp_f32 v123, v123
    s_waitcnt lgkmcnt(4)
    v_mfma_f32_32x32x16_bf16 v[160:175], v[232:235], v[64:67], v[160:175]
    ds_read_b64_tr_b16 v[228:229], v247 offset:16384
    ds_read_b64_tr_b16 v[230:231], v248 offset:17408
    v_add_f32 v252, v252, v72
    v_add_f32 v253, v253, v73
    v_cvt_pk_bf16_f32 v72, v72, v73
    v_add_f32 v252, v252, v74
    v_exp_f32 v109, v109
    s_waitcnt lgkmcnt(4)
    v_mfma_f32_32x32x16_bf16 v[176:191], v[236:239], v[64:67], v[176:191]
    ds_read_b64_tr_b16 v[232:233], v245 offset:2048
    ds_read_b64_tr_b16 v[234:235], v246 offset:3072
    v_add_f32 v253, v253, v75
    v_cvt_pk_bf16_f32 v73, v74, v75
    v_add_f32 v252, v252, v76
    v_add_f32 v253, v253, v77
    v_fmamk_f32 v125, v125, 0x3dd53b95, v250
    s_waitcnt lgkmcnt(4)
    v_mfma_f32_32x32x16_bf16 v[192:207], v[224:227], v[64:67], v[192:207]
    ds_read_b64_tr_b16 v[236:237], v247 offset:2048
    ds_read_b64_tr_b16 v[238:239], v248 offset:3072
    v_cvt_pk_bf16_f32 v74, v76, v77
    v_add_f32 v252, v252, v78
    v_add_f32 v253, v253, v79
    v_cvt_pk_bf16_f32 v75, v78, v79
    v_fmamk_f32 v111, v111, 0x3dd53b95, v250
    s_waitcnt lgkmcnt(4)
    v_mfma_f32_32x32x16_bf16 v[208:223], v[228:231], v[64:67], v[208:223]
    ds_read_b64_tr_b16 v[224:225], v245 offset:10240
    ds_read_b64_tr_b16 v[226:227], v246 offset:11264
    v_exp_f32 v124, v124
    v_xor_b32 v254, s7, v244
    s_add_u32 m0, s36, 3072
    s_add_u32 s31, s30, s5
    s_add_u32 s31, s31, 9472
    buffer_load_dwordx4 v254, s[12:15], s31 offen nt lds
    s_waitcnt lgkmcnt(4)
    v_mfma_f32_32x32x16_bf16 v[128:143], v[232:235], v[72:75], v[128:143]
    ds_read_b64_tr_b16 v[228:229], v247 offset:10240
    ds_read_b64_tr_b16 v[230:231], v248 offset:11264
    v_mul_f32 v80, v255, v80
    v_mul_f32 v81, v255, v81
    v_mul_f32 v82, v255, v82
    v_mul_f32 v83, v255, v83
    v_exp_f32 v110, v110
    v_fmamk_f32 v126, v126, 0x3dd53b95, v250
    s_waitcnt lgkmcnt(4)
    v_mfma_f32_32x32x16_bf16 v[144:159], v[236:239], v[72:75], v[144:159]
    ds_read_b64_tr_b16 v[232:233], v245 offset:18432
    ds_read_b64_tr_b16 v[234:235], v246 offset:19456
    v_mul_f32 v84, v255, v84
    v_mul_f32 v85, v255, v85
    v_mul_f32 v86, v255, v86
    v_mul_f32 v87, v255, v87
    s_waitcnt lgkmcnt(4)
    v_mfma_f32_32x32x16_bf16 v[160:175], v[224:227], v[72:75], v[160:175]
    ds_read_b64_tr_b16 v[236:237], v247 offset:18432
    ds_read_b64_tr_b16 v[238:239], v248 offset:19456
    v_add_f32 v252, v252, v80
    v_add_f32 v253, v253, v81
    v_cvt_pk_bf16_f32 v80, v80, v81
    v_add_f32 v252, v252, v82
    v_exp_f32 v111, v111
    v_exp_f32 v125, v125
    s_waitcnt lgkmcnt(4)
    v_mfma_f32_32x32x16_bf16 v[176:191], v[228:231], v[72:75], v[176:191]
    ds_read_b64_tr_b16 v[224:225], v245 offset:4096
    ds_read_b64_tr_b16 v[226:227], v246 offset:5120
    v_add_f32 v253, v253, v83
    v_cvt_pk_bf16_f32 v81, v82, v83
    v_add_f32 v252, v252, v84
    v_add_f32 v253, v253, v85
    s_waitcnt lgkmcnt(4)
    v_mfma_f32_32x32x16_bf16 v[192:207], v[232:235], v[72:75], v[192:207]
    ds_read_b64_tr_b16 v[228:229], v247 offset:4096
    ds_read_b64_tr_b16 v[230:231], v248 offset:5120
    v_cvt_pk_bf16_f32 v82, v84, v85
    v_add_f32 v252, v252, v86
    v_add_f32 v253, v253, v87
    v_cvt_pk_bf16_f32 v83, v86, v87
    v_fmamk_f32 v127, v127, 0x3dd53b95, v250
    s_waitcnt lgkmcnt(4)
    v_mfma_f32_32x32x16_bf16 v[208:223], v[236:239], v[72:75], v[208:223]
    ds_read_b64_tr_b16 v[232:233], v245 offset:12288
    ds_read_b64_tr_b16 v[234:235], v246 offset:13312
    s_waitcnt lgkmcnt(4)
    v_mfma_f32_32x32x16_bf16 v[128:143], v[224:227], v[80:83], v[128:143]
    ds_read_b64_tr_b16 v[236:237], v247 offset:12288
    ds_read_b64_tr_b16 v[238:239], v248 offset:13312
    v_mul_f32 v88, v255, v88
    v_mul_f32 v89, v255, v89
    v_mul_f32 v90, v255, v90
    v_mul_f32 v91, v255, v91
    v_exp_f32 v126, v126
    s_waitcnt lgkmcnt(4)
    v_mfma_f32_32x32x16_bf16 v[144:159], v[228:231], v[80:83], v[144:159]
    ds_read_b64_tr_b16 v[224:225], v245 offset:20480
    ds_read_b64_tr_b16 v[226:227], v246 offset:21504
    v_mul_f32 v92, v255, v92
    v_mul_f32 v93, v255, v93
    v_mul_f32 v94, v255, v94
    v_mul_f32 v95, v255, v95
    s_waitcnt lgkmcnt(4)
    v_mfma_f32_32x32x16_bf16 v[160:175], v[232:235], v[80:83], v[160:175]
    ds_read_b64_tr_b16 v[228:229], v247 offset:20480
    ds_read_b64_tr_b16 v[230:231], v248 offset:21504
    v_add_f32 v252, v252, v88
    v_add_f32 v253, v253, v89
    v_cvt_pk_bf16_f32 v88, v88, v89
    v_add_f32 v252, v252, v90
    v_exp_f32 v127, v127
    s_waitcnt lgkmcnt(4)
    v_mfma_f32_32x32x16_bf16 v[176:191], v[236:239], v[80:83], v[176:191]
    ds_read_b64_tr_b16 v[232:233], v245 offset:6144
    ds_read_b64_tr_b16 v[234:235], v246 offset:7168
    v_add_f32 v253, v253, v91
    v_cvt_pk_bf16_f32 v89, v90, v91
    v_add_f32 v252, v252, v92
    v_add_f32 v253, v253, v93
    s_waitcnt lgkmcnt(4)
    v_mfma_f32_32x32x16_bf16 v[192:207], v[224:227], v[80:83], v[192:207]
    ds_read_b64_tr_b16 v[236:237], v247 offset:6144
    ds_read_b64_tr_b16 v[238:239], v248 offset:7168
    v_cvt_pk_bf16_f32 v90, v92, v93
    v_add_f32 v252, v252, v94
    v_add_f32 v253, v253, v95
    v_cvt_pk_bf16_f32 v91, v94, v95
    s_waitcnt lgkmcnt(4)
    v_mfma_f32_32x32x16_bf16 v[208:223], v[228:231], v[80:83], v[208:223]
    ds_read_b64_tr_b16 v[224:225], v245 offset:14336
    ds_read_b64_tr_b16 v[226:227], v246 offset:15360
    s_waitcnt lgkmcnt(4)
    v_mfma_f32_32x32x16_bf16 v[128:143], v[232:235], v[88:91], v[128:143]
    ds_read_b64_tr_b16 v[228:229], v247 offset:14336
    ds_read_b64_tr_b16 v[230:231], v248 offset:15360
    v_add_f32 v252, v252, v96
    v_add_f32 v253, v253, v97
    v_cvt_pk_bf16_f32 v96, v96, v97
    s_waitcnt lgkmcnt(4)
    v_mfma_f32_32x32x16_bf16 v[144:159], v[236:239], v[88:91], v[144:159]
    ds_read_b64_tr_b16 v[232:233], v245 offset:22528
    ds_read_b64_tr_b16 v[234:235], v246 offset:23552
    v_add_f32 v252, v252, v98
    v_add_f32 v253, v253, v99
    s_waitcnt lgkmcnt(4)
    v_mfma_f32_32x32x16_bf16 v[160:175], v[224:227], v[88:91], v[160:175]
    ds_read_b64_tr_b16 v[236:237], v247 offset:22528
    ds_read_b64_tr_b16 v[238:239], v248 offset:23552
    v_cvt_pk_bf16_f32 v97, v98, v99
    v_add_f32 v252, v252, v100
    v_add_f32 v253, v253, v101
    s_waitcnt lgkmcnt(4)
    v_mfma_f32_32x32x16_bf16 v[176:191], v[228:231], v[88:91], v[176:191]
    s_waitcnt vmcnt(1)
    s_barrier
    v_add_u32 v245, 73728, v251
    v_xor_b32 v246, 16, v245
    v_xor_b32 v247, 64, v245
    v_xor_b32 v248, 0x50, v245
    ds_read_b64_tr_b16 v[224:225], v245 offset:0
    ds_read_b64_tr_b16 v[226:227], v246 offset:1024
    s_add_u32 m0, s28, 0
    s_add_u32 s31, s30, 0
    buffer_load_dwordx4 v244, s[16:19], s31 offen offset:0 nt lds
    v_cvt_pk_bf16_f32 v98, v100, v101
    v_add_f32 v252, v252, v102
    s_waitcnt lgkmcnt(4)
    v_mfma_f32_32x32x16_bf16 v[192:207], v[232:235], v[88:91], v[192:207]
    ds_read_b64_tr_b16 v[228:229], v247 offset:0
    ds_read_b64_tr_b16 v[230:231], v248 offset:1024
    s_add_u32 m0, s28, 8064
    s_add_u32 s31, s30, 0
    buffer_load_dwordx4 v244, s[16:19], s31 offen offset:128 nt lds
    v_add_f32 v253, v253, v103
    v_cvt_pk_bf16_f32 v99, v102, v103
    s_waitcnt lgkmcnt(4)
    v_mfma_f32_32x32x16_bf16 v[208:223], v[236:239], v[88:91], v[208:223]
    ds_read_b64_tr_b16 v[232:233], v245 offset:8192
    ds_read_b64_tr_b16 v[234:235], v246 offset:9216
    s_add_u32 m0, s28, 16128
    s_add_u32 s31, s30, 0
    buffer_load_dwordx4 v244, s[16:19], s31 offen offset:256 nt lds
    s_waitcnt lgkmcnt(4)
    v_mfma_f32_32x32x16_bf16 v[128:143], v[224:227], v[96:99], v[128:143]
    ds_read_b64_tr_b16 v[236:237], v247 offset:8192
    ds_read_b64_tr_b16 v[238:239], v248 offset:9216
    v_add_f32 v252, v252, v104
    v_add_f32 v253, v253, v105
    v_cvt_pk_bf16_f32 v104, v104, v105
    v_add_f32 v252, v252, v112
    v_add_f32 v253, v253, v113
    s_waitcnt lgkmcnt(4)
    v_mfma_f32_32x32x16_bf16 v[144:159], v[228:231], v[96:99], v[144:159]
    ds_read_b64_tr_b16 v[224:225], v245 offset:16384
    ds_read_b64_tr_b16 v[226:227], v246 offset:17408
    v_add_f32 v252, v252, v106
    v_add_f32 v253, v253, v107
    v_cvt_pk_bf16_f32 v112, v112, v113
    v_add_f32 v252, v252, v120
    v_add_f32 v253, v253, v121
    s_waitcnt lgkmcnt(4)
    v_mfma_f32_32x32x16_bf16 v[160:175], v[232:235], v[96:99], v[160:175]
    ds_read_b64_tr_b16 v[228:229], v247 offset:16384
    ds_read_b64_tr_b16 v[230:231], v248 offset:17408
    v_cvt_pk_bf16_f32 v105, v106, v107
    v_add_f32 v252, v252, v108
    v_add_f32 v253, v253, v109
    v_add_f32 v252, v252, v114
    v_cvt_pk_bf16_f32 v120, v120, v121
    s_waitcnt lgkmcnt(4)
    v_mfma_f32_32x32x16_bf16 v[176:191], v[236:239], v[96:99], v[176:191]
    ds_read_b64_tr_b16 v[232:233], v245 offset:2048
    ds_read_b64_tr_b16 v[234:235], v246 offset:3072
    v_cvt_pk_bf16_f32 v106, v108, v109
    v_add_f32 v252, v252, v110
    v_add_f32 v253, v253, v115
    v_add_f32 v252, v252, v122
    s_waitcnt lgkmcnt(4)
    v_mfma_f32_32x32x16_bf16 v[192:207], v[224:227], v[96:99], v[192:207]
    ds_read_b64_tr_b16 v[236:237], v247 offset:2048
    ds_read_b64_tr_b16 v[238:239], v248 offset:3072
    v_add_f32 v253, v253, v111
    v_cvt_pk_bf16_f32 v107, v110, v111
    v_cvt_pk_bf16_f32 v113, v114, v115
    v_add_f32 v253, v253, v123
    s_waitcnt lgkmcnt(4)
    v_mfma_f32_32x32x16_bf16 v[208:223], v[228:231], v[96:99], v[208:223]
    ds_read_b64_tr_b16 v[224:225], v245 offset:10240
    ds_read_b64_tr_b16 v[226:227], v246 offset:11264
    v_add_f32 v252, v252, v116
    v_cvt_pk_bf16_f32 v121, v122, v123
    s_waitcnt lgkmcnt(4)
    v_mfma_f32_32x32x16_bf16 v[128:143], v[232:235], v[104:107], v[128:143]
    ds_read_b64_tr_b16 v[228:229], v247 offset:10240
    ds_read_b64_tr_b16 v[230:231], v248 offset:11264
    v_add_f32 v253, v253, v117
    v_add_f32 v252, v252, v124
    v_add_f32 v253, v253, v125
    s_waitcnt lgkmcnt(4)
    v_mfma_f32_32x32x16_bf16 v[144:159], v[236:239], v[104:107], v[144:159]
    ds_read_b64_tr_b16 v[232:233], v245 offset:18432
    ds_read_b64_tr_b16 v[234:235], v246 offset:19456
    v_cvt_pk_bf16_f32 v114, v116, v117
    v_cvt_pk_bf16_f32 v122, v124, v125
    s_waitcnt lgkmcnt(4)
    v_mfma_f32_32x32x16_bf16 v[160:175], v[224:227], v[104:107], v[160:175]
    ds_read_b64_tr_b16 v[236:237], v247 offset:18432
    ds_read_b64_tr_b16 v[238:239], v248 offset:19456
    v_add_f32 v252, v252, v118
    v_add_f32 v252, v252, v126
    s_waitcnt lgkmcnt(4)
    v_mfma_f32_32x32x16_bf16 v[176:191], v[228:231], v[104:107], v[176:191]
    ds_read_b64_tr_b16 v[224:225], v245 offset:20480
    ds_read_b64_tr_b16 v[226:227], v246 offset:21504
    v_add_f32 v253, v253, v119
    v_add_f32 v253, v253, v127
    s_waitcnt lgkmcnt(4)
    v_mfma_f32_32x32x16_bf16 v[192:207], v[232:235], v[104:107], v[192:207]
    ds_read_b64_tr_b16 v[228:229], v245 offset:22528
    ds_read_b64_tr_b16 v[230:231], v246 offset:23552
    v_cvt_pk_bf16_f32 v115, v118, v119
    v_cvt_pk_bf16_f32 v123, v126, v127
    s_waitcnt lgkmcnt(4)
    v_mfma_f32_32x32x16_bf16 v[208:223], v[236:239], v[104:107], v[208:223]
    ds_read_b64_tr_b16 v[232:233], v247 offset:20480
    ds_read_b64_tr_b16 v[234:235], v248 offset:21504
    s_waitcnt lgkmcnt(4)
    v_mfma_f32_32x32x16_bf16 v[192:207], v[224:227], v[112:115], v[192:207]
    ds_read_b64_tr_b16 v[236:237], v247 offset:22528
    ds_read_b64_tr_b16 v[238:239], v248 offset:23552
    v_add_f32 v252, v252, v253
    v_mov_b32 v254, v252
    s_nop 1
    v_permlane32_swap_b32 v252, v254
    s_nop 1
    v_add_f32 v252, v252, v254
    v_rcp_f32 v243, v252
    s_waitcnt vmcnt(3)
    v_add_u32 v0, s36, v249
    v_xor_b32 v1, 32, v0
    v_xor_b32 v2, 64, v0
    v_xor_b32 v3, 96, v0
    ds_read_b128 v[48:51], v0
    ds_read_b128 v[52:55], v1
    ds_read_b128 v[56:59], v2
    ds_read_b128 v[60:63], v3
    s_waitcnt lgkmcnt(8)
    v_mfma_f32_32x32x16_bf16 v[192:207], v[228:231], v[120:123], v[192:207]
    ds_read_b64_tr_b16 v[224:225], v245 offset:12288
    ds_read_b64_tr_b16 v[226:227], v246 offset:13312
    s_waitcnt lgkmcnt(8)
    v_mfma_f32_32x32x16_bf16 v[208:223], v[232:235], v[112:115], v[208:223]
    ds_read_b64_tr_b16 v[228:229], v245 offset:14336
    ds_read_b64_tr_b16 v[230:231], v246 offset:15360
    s_waitcnt lgkmcnt(8)
    v_mfma_f32_32x32x16_bf16 v[208:223], v[236:239], v[120:123], v[208:223]
    ds_read_b64_tr_b16 v[232:233], v247 offset:12288
    ds_read_b64_tr_b16 v[234:235], v248 offset:13312
    s_waitcnt lgkmcnt(4)
    v_mfma_f32_32x32x16_bf16 v[160:175], v[224:227], v[112:115], v[160:175]
    ds_read_b64_tr_b16 v[236:237], v247 offset:14336
    ds_read_b64_tr_b16 v[238:239], v248 offset:15360
    s_waitcnt lgkmcnt(4)
    v_mfma_f32_32x32x16_bf16 v[160:175], v[228:231], v[120:123], v[160:175]
    ds_read_b64_tr_b16 v[224:225], v245 offset:4096
    ds_read_b64_tr_b16 v[226:227], v246 offset:5120
    s_waitcnt lgkmcnt(4)
    v_mfma_f32_32x32x16_bf16 v[176:191], v[232:235], v[112:115], v[176:191]
    ds_read_b64_tr_b16 v[228:229], v245 offset:6144
    ds_read_b64_tr_b16 v[230:231], v246 offset:7168
    s_waitcnt lgkmcnt(4)
    v_mfma_f32_32x32x16_bf16 v[176:191], v[236:239], v[120:123], v[176:191]
    ds_read_b64_tr_b16 v[232:233], v247 offset:4096
    ds_read_b64_tr_b16 v[234:235], v248 offset:5120
    v_mul_f32 v192, v243, v192
    v_mul_f32 v193, v243, v193
    v_mul_f32 v194, v243, v194
    v_mul_f32 v195, v243, v195
    v_cvt_pk_bf16_f32 v192, v192, v193
    s_waitcnt lgkmcnt(4)
    v_mfma_f32_32x32x16_bf16 v[128:143], v[224:227], v[112:115], v[128:143]
    ds_read_b64_tr_b16 v[236:237], v247 offset:6144
    ds_read_b64_tr_b16 v[238:239], v248 offset:7168
    v_cvt_pk_bf16_f32 v193, v194, v195
    ds_write_b64 v240, v[192:193]
    v_mul_f32 v196, v243, v196
    v_mul_f32 v197, v243, v197
    v_mul_f32 v198, v243, v198
    s_waitcnt lgkmcnt(5)
    v_mfma_f32_32x32x16_bf16 v[128:143], v[228:231], v[120:123], v[128:143]
    s_waitcnt vmcnt(0)
    s_barrier
    v_add_u32 v245, 0, v249
    v_xor_b32 v246, 32, v245
    v_xor_b32 v247, 64, v245
    v_xor_b32 v248, 96, v245
    ds_read_b128 v[224:227], v245 offset:0
    s_add_u32 m0, s28, 24576
    s_add_u32 s31, s30, 24576
    buffer_load_dwordx4 v244, s[16:19], s31 offen offset:0 nt lds
    v_mul_f32 v199, v243, v199
    v_cvt_pk_bf16_f32 v196, v196, v197
    v_cvt_pk_bf16_f32 v197, v198, v199
    v_xor_b32 v254, 16, v240
    ds_write_b64 v254, v[196:197]
    s_waitcnt lgkmcnt(5)
    v_mfma_f32_32x32x16_bf16 v[144:159], v[232:235], v[112:115], v[144:159]
    ds_read_b128 v[228:231], v246 offset:0
    s_add_u32 m0, s28, 32640
    s_add_u32 s31, s30, 24576
    buffer_load_dwordx4 v244, s[16:19], s31 offen offset:128 nt lds
    v_mul_f32 v200, v243, v200
    v_mul_f32 v201, v243, v201
    v_mul_f32 v202, v243, v202
    v_mul_f32 v203, v243, v203
    v_cvt_pk_bf16_f32 v200, v200, v201
    s_waitcnt lgkmcnt(4)
    v_mfma_f32_32x32x16_bf16 v[144:159], v[236:239], v[120:123], v[144:159]
    ds_read_b128 v[232:235], v247 offset:0
    s_add_u32 m0, s28, 40704
    s_add_u32 s31, s30, 24576
    buffer_load_dwordx4 v244, s[16:19], s31 offen offset:256 nt lds
    v_cvt_pk_bf16_f32 v201, v202, v203
    v_xor_b32 v254, 32, v240
    ds_write_b64 v254, v[200:201]
    v_mul_f32 v204, v243, v204
    v_mul_f32 v205, v243, v205
    s_waitcnt lgkmcnt(15)
    s_waitcnt lgkmcnt(15)
    s_waitcnt lgkmcnt(4)
    v_mfma_f32_32x32x16_bf16 v[64:79], v[224:227], v[16:19], 0
    ds_read_b128 v[236:239], v248 offset:0
    v_mul_f32 v206, v243, v206
    v_mul_f32 v207, v243, v207
    v_cvt_pk_bf16_f32 v204, v204, v205
    v_cvt_pk_bf16_f32 v205, v206, v207
    v_xor_b32 v254, 48, v240
    ds_write_b64 v254, v[204:205]
    s_waitcnt lgkmcnt(4)
    v_mfma_f32_32x32x16_bf16 v[64:79], v[228:231], v[20:23], v[64:79]
    ds_read_b128 v[224:227], v245 offset:8192
    v_mul_f32 v208, v243, v208
    v_mul_f32 v209, v243, v209
    v_mul_f32 v210, v243, v210
    s_waitcnt lgkmcnt(4)
    v_mfma_f32_32x32x16_bf16 v[64:79], v[232:235], v[24:27], v[64:79]
    ds_read_b128 v[228:231], v246 offset:8192
    v_mul_f32 v211, v243, v211
    v_cvt_pk_bf16_f32 v208, v208, v209
    v_cvt_pk_bf16_f32 v209, v210, v211
    v_xor_b32 v254, 64, v240
    ds_write_b64 v254, v[208:209]
    s_waitcnt lgkmcnt(4)
    v_mfma_f32_32x32x16_bf16 v[64:79], v[236:239], v[28:31], v[64:79]
    ds_read_b128 v[232:235], v247 offset:8192
    v_mul_f32 v212, v243, v212
    v_mul_f32 v213, v243, v213
    v_mul_f32 v214, v243, v214
    v_mul_f32 v215, v243, v215
    v_cvt_pk_bf16_f32 v212, v212, v213
    s_waitcnt lgkmcnt(3)
    v_mfma_f32_32x32x16_bf16 v[64:79], v[224:227], v[32:35], v[64:79]
    ds_read_b128 v[236:239], v248 offset:8192
    v_cvt_pk_bf16_f32 v213, v214, v215
    v_xor_b32 v254, 80, v240
    ds_write_b64 v254, v[212:213]
    v_mul_f32 v216, v243, v216
    v_mul_f32 v217, v243, v217
    s_waitcnt lgkmcnt(4)
    v_mfma_f32_32x32x16_bf16 v[64:79], v[228:231], v[36:39], v[64:79]
    ds_read_b128 v[224:227], v245 offset:16384
    v_mul_f32 v218, v243, v218
    v_mul_f32 v219, v243, v219
    v_cvt_pk_bf16_f32 v216, v216, v217
    v_cvt_pk_bf16_f32 v217, v218, v219
    v_xor_b32 v254, 96, v240
    ds_write_b64 v254, v[216:217]
    s_waitcnt lgkmcnt(4)
    v_mfma_f32_32x32x16_bf16 v[64:79], v[232:235], v[40:43], v[64:79]
    ds_read_b128 v[228:231], v246 offset:16384
    v_mul_f32 v220, v243, v220
    v_mul_f32 v221, v243, v221
    v_mul_f32 v222, v243, v222
    v_mul_f32 v223, v243, v223
    s_waitcnt lgkmcnt(4)
    v_mfma_f32_32x32x16_bf16 v[64:79], v[236:239], v[44:47], v[64:79]
    ds_read_b128 v[232:235], v247 offset:16384
    v_cvt_pk_bf16_f32 v220, v220, v221
    v_cvt_pk_bf16_f32 v221, v222, v223
    v_xor_b32 v254, 112, v240
    ds_write_b64 v254, v[220:221]
    s_waitcnt lgkmcnt(15)
    s_waitcnt lgkmcnt(4)
    v_mfma_f32_32x32x16_bf16 v[64:79], v[224:227], v[48:51], v[64:79]
    ds_read_b128 v[236:239], v248 offset:16384
    v_mul_f32 v160, v243, v160
    v_mul_f32 v161, v243, v161
    v_mul_f32 v162, v243, v162
    v_mul_f32 v163, v243, v163
    v_cvt_pk_bf16_f32 v160, v160, v161
    v_cvt_pk_bf16_f32 v161, v162, v163
    s_waitcnt lgkmcnt(3)
    v_mfma_f32_32x32x16_bf16 v[64:79], v[228:231], v[52:55], v[64:79]
    ds_read_b128 v[224:227], v245 offset:4096
    ds_write_b64 v240, v[160:161] offset:4096
    v_mul_f32 v164, v243, v164
    v_mul_f32 v165, v243, v165
    v_mul_f32 v166, v243, v166
    v_mul_f32 v167, v243, v167
    v_cvt_pk_bf16_f32 v164, v164, v165
    s_waitcnt lgkmcnt(4)
    v_mfma_f32_32x32x16_bf16 v[64:79], v[232:235], v[56:59], v[64:79]
    ds_read_b128 v[228:231], v246 offset:4096
    v_cvt_pk_bf16_f32 v165, v166, v167
    v_xor_b32 v254, 16, v240
    ds_write_b64 v254, v[164:165] offset:4096
    v_mul_f32 v168, v243, v168
    v_mul_f32 v169, v243, v169
    v_mul_f32 v170, v243, v170
    s_waitcnt lgkmcnt(4)
    v_mfma_f32_32x32x16_bf16 v[64:79], v[236:239], v[60:63], v[64:79]
    ds_read_b128 v[232:235], v247 offset:4096
    v_mul_f32 v171, v243, v171
    v_cvt_pk_bf16_f32 v168, v168, v169
    v_cvt_pk_bf16_f32 v169, v170, v171
    v_xor_b32 v254, 32, v240
    ds_write_b64 v254, v[168:169] offset:4096
    s_waitcnt lgkmcnt(5)
    v_mfma_f32_32x32x16_bf16 v[80:95], v[224:227], v[16:19], 0
    ds_read_b128 v[236:239], v248 offset:4096
    v_mul_f32 v172, v243, v172
    v_mul_f32 v173, v243, v173
    v_mul_f32 v174, v243, v174
    v_mul_f32 v175, v243, v175
    v_cvt_pk_bf16_f32 v172, v172, v173
    v_cvt_pk_bf16_f32 v173, v174, v175
    s_waitcnt lgkmcnt(4)
    v_mfma_f32_32x32x16_bf16 v[80:95], v[228:231], v[20:23], v[80:95]
    ds_read_b128 v[224:227], v245 offset:12288
    v_xor_b32 v254, 48, v240
    ds_write_b64 v254, v[172:173] offset:4096
    v_mul_f32 v176, v243, v176
    v_mul_f32 v177, v243, v177
    v_mul_f32 v178, v243, v178
    v_mul_f32 v179, v243, v179
    ds_read_b128 v[216:219], v241 offset:0
    s_waitcnt lgkmcnt(5)
    v_mfma_f32_32x32x16_bf16 v[80:95], v[232:235], v[24:27], v[80:95]
    ds_read_b128 v[228:231], v246 offset:12288
    v_cvt_pk_bf16_f32 v176, v176, v177
    v_cvt_pk_bf16_f32 v177, v178, v179
    v_xor_b32 v254, 64, v240
    ds_write_b64 v254, v[176:177] offset:4096
    v_mul_f32 v180, v243, v180
    v_mul_f32 v181, v243, v181
    s_waitcnt lgkmcnt(5)
    v_mfma_f32_32x32x16_bf16 v[80:95], v[236:239], v[28:31], v[80:95]
    ds_read_b128 v[232:235], v247 offset:12288
    v_mul_f32 v182, v243, v182
    v_mul_f32 v183, v243, v183
    v_cvt_pk_bf16_f32 v180, v180, v181
    v_cvt_pk_bf16_f32 v181, v182, v183
    v_xor_b32 v254, 80, v240
    ds_write_b64 v254, v[180:181] offset:4096
    s_waitcnt lgkmcnt(6)
    v_mfma_f32_32x32x16_bf16 v[80:95], v[224:227], v[32:35], v[80:95]
    ds_read_b128 v[236:239], v248 offset:12288
    v_max3_f32 v208, v64, v65, v66
    v_max3_f32 v208, v208, v67, v68
    v_max3_f32 v208, v208, v69, v70
    v_mul_f32 v184, v243, v184
    v_mul_f32 v185, v243, v185
    v_mul_f32 v186, v243, v186
    v_mul_f32 v187, v243, v187
    v_cvt_pk_bf16_f32 v184, v184, v185
    s_waitcnt lgkmcnt(4)
    v_mfma_f32_32x32x16_bf16 v[80:95], v[228:231], v[36:39], v[80:95]
    ds_read_b128 v[224:227], v245 offset:20480
    v_max3_f32 v208, v208, v71, v72
    v_max3_f32 v208, v208, v73, v74
    v_cvt_pk_bf16_f32 v185, v186, v187
    v_xor_b32 v254, 96, v240
    ds_write_b64 v254, v[184:185] offset:4096
    v_mul_f32 v188, v243, v188
    v_mul_f32 v189, v243, v189
    v_mul_f32 v190, v243, v190
    s_waitcnt lgkmcnt(4)
    v_mfma_f32_32x32x16_bf16 v[80:95], v[232:235], v[40:43], v[80:95]
    ds_read_b128 v[228:231], v246 offset:20480
    v_max3_f32 v208, v208, v75, v76
    v_max3_f32 v208, v208, v77, v78
    v_mul_f32 v191, v243, v191
    v_cvt_pk_bf16_f32 v188, v188, v189
    v_cvt_pk_bf16_f32 v189, v190, v191
    v_xor_b32 v254, 112, v240
    ds_write_b64 v254, v[188:189] offset:4096
    s_waitcnt lgkmcnt(9)
    s_add_u32 s38, s39, 0
    buffer_store_dwordx4 v[216:219], v242, s[24:27], s38 offen offset:256 nt
    s_waitcnt lgkmcnt(4)
    v_mfma_f32_32x32x16_bf16 v[80:95], v[236:239], v[44:47], v[80:95]
    ds_read_b128 v[232:235], v247 offset:20480
    v_max_f32 v208, v208, v79
    v_mul_f32 v208, s32, v208
    v_mul_f32 v128, v243, v128
    v_mul_f32 v129, v243, v129
    v_mul_f32 v130, v243, v130
    v_mul_f32 v131, v243, v131
    s_waitcnt lgkmcnt(4)
    v_mfma_f32_32x32x16_bf16 v[80:95], v[224:227], v[48:51], v[80:95]
    ds_read_b128 v[236:239], v248 offset:20480
    v_fmamk_f32 v64, v64, 0x3dd53b95, v208
    v_fmamk_f32 v65, v65, 0x3dd53b95, v208
    v_exp_f32 v64, v64
    v_cvt_pk_bf16_f32 v128, v128, v129
    v_cvt_pk_bf16_f32 v129, v130, v131
    v_mul_f32 v132, v243, v132
    v_mul_f32 v133, v243, v133
    s_waitcnt lgkmcnt(3)
    v_mfma_f32_32x32x16_bf16 v[80:95], v[228:231], v[52:55], v[80:95]
    s_waitcnt vmcnt(1)
    s_barrier
    v_add_u32 v245, 24576, v249
    v_xor_b32 v246, 32, v245
    v_xor_b32 v247, 64, v245
    v_xor_b32 v248, 96, v245
    ds_read_b128 v[224:227], v245 offset:0
    s_add_u32 m0, s28, 49152
    s_add_u32 s31, s30, 49152
    buffer_load_dwordx4 v244, s[16:19], s31 offen offset:0 nt lds
    v_fmamk_f32 v66, v66, 0x3dd53b95, v208
    v_exp_f32 v65, v65
    v_fmamk_f32 v67, v67, 0x3dd53b95, v208
    v_mul_f32 v134, v243, v134
    v_mul_f32 v135, v243, v135
    v_cvt_pk_bf16_f32 v132, v132, v133
    v_cvt_pk_bf16_f32 v133, v134, v135
    s_waitcnt lgkmcnt(2)
    v_mfma_f32_32x32x16_bf16 v[80:95], v[232:235], v[56:59], v[80:95]
    ds_read_b128 v[228:231], v246 offset:0
    s_add_u32 m0, s28, 57216
    s_add_u32 s31, s30, 49152
    buffer_load_dwordx4 v244, s[16:19], s31 offen offset:128 nt lds
    v_exp_f32 v66, v66
    v_fmamk_f32 v68, v68, 0x3dd53b95, v208
    v_mul_f32 v136, v243, v136
    v_mul_f32 v137, v243, v137
    v_mul_f32 v138, v243, v138
    v_mul_f32 v139, v243, v139
    s_waitcnt lgkmcnt(2)
    v_mfma_f32_32x32x16_bf16 v[80:95], v[236:239], v[60:63], v[80:95]
    ds_read_b128 v[232:235], v247 offset:0
    s_add_u32 m0, s28, 65280
    s_add_u32 s31, s30, 49152
    buffer_load_dwordx4 v244, s[16:19], s31 offen offset:256 nt lds
    v_exp_f32 v67, v67
    v_fmamk_f32 v69, v69, 0x3dd53b95, v208
    v_exp_f32 v68, v68
    v_cvt_pk_bf16_f32 v136, v136, v137
    v_cvt_pk_bf16_f32 v137, v138, v139
    v_mul_f32 v140, v243, v140
    v_mul_f32 v141, v243, v141
    s_waitcnt lgkmcnt(2)
    v_mfma_f32_32x32x16_bf16 v[96:111], v[224:227], v[16:19], 0
    ds_read_b128 v[236:239], v248 offset:0
    v_fmamk_f32 v70, v70, 0x3dd53b95, v208
    v_exp_f32 v69, v69
    v_fmamk_f32 v71, v71, 0x3dd53b95, v208
    v_mul_f32 v142, v243, v142
    v_mul_f32 v143, v243, v143
    v_cvt_pk_bf16_f32 v140, v140, v141
    v_cvt_pk_bf16_f32 v141, v142, v143
    s_waitcnt lgkmcnt(2)
    v_mfma_f32_32x32x16_bf16 v[96:111], v[228:231], v[20:23], v[96:111]
    ds_read_b128 v[224:227], v245 offset:8192
    v_exp_f32 v70, v70
    v_fmamk_f32 v72, v72, 0x3dd53b95, v208
    ds_read_b128 v[216:219], v241 offset:1024
    v_mul_f32 v144, v243, v144
    v_mul_f32 v145, v243, v145
    v_mul_f32 v146, v243, v146
    v_mul_f32 v147, v243, v147
    s_waitcnt lgkmcnt(3)
    v_mfma_f32_32x32x16_bf16 v[96:111], v[232:235], v[24:27], v[96:111]
    ds_read_b128 v[228:231], v246 offset:8192
    v_exp_f32 v71, v71
    v_fmamk_f32 v73, v73, 0x3dd53b95, v208
    v_exp_f32 v72, v72
    v_cvt_pk_bf16_f32 v144, v144, v145
    v_cvt_pk_bf16_f32 v145, v146, v147
    v_mul_f32 v148, v243, v148
    v_mul_f32 v149, v243, v149
    s_waitcnt lgkmcnt(3)
    v_mfma_f32_32x32x16_bf16 v[96:111], v[236:239], v[28:31], v[96:111]
    ds_read_b128 v[232:235], v247 offset:8192
    v_fmamk_f32 v74, v74, 0x3dd53b95, v208
    v_exp_f32 v73, v73
    v_fmamk_f32 v75, v75, 0x3dd53b95, v208
    v_mul_f32 v150, v243, v150
    v_mul_f32 v151, v243, v151
    v_cvt_pk_bf16_f32 v148, v148, v149
    v_cvt_pk_bf16_f32 v149, v150, v151
    s_waitcnt lgkmcnt(3)
    v_mfma_f32_32x32x16_bf16 v[96:111], v[224:227], v[32:35], v[96:111]
    ds_read_b128 v[236:239], v248 offset:8192
    v_max3_f32 v209, v80, v81, v82
    v_max3_f32 v209, v209, v83, v84
    v_max3_f32 v209, v209, v85, v86
    v_exp_f32 v74, v74
    v_fmamk_f32 v76, v76, 0x3dd53b95, v208
    v_mul_f32 v152, v243, v152
    v_mul_f32 v153, v243, v153
    v_mul_f32 v154, v243, v154
    v_mul_f32 v155, v243, v155
    s_waitcnt lgkmcnt(2)
    v_mfma_f32_32x32x16_bf16 v[96:111], v[228:231], v[36:39], v[96:111]
    ds_read_b128 v[224:227], v245 offset:16384
    v_max3_f32 v209, v209, v87, v88
    v_max3_f32 v209, v209, v89, v90
    v_exp_f32 v75, v75
    v_fmamk_f32 v77, v77, 0x3dd53b95, v208
    v_exp_f32 v76, v76
    v_cvt_pk_bf16_f32 v152, v152, v153
    v_cvt_pk_bf16_f32 v153, v154, v155
    v_mul_f32 v156, v243, v156
    v_mul_f32 v157, v243, v157
    s_waitcnt lgkmcnt(2)
    v_mfma_f32_32x32x16_bf16 v[96:111], v[232:235], v[40:43], v[96:111]
    ds_read_b128 v[228:231], v246 offset:16384
    v_max3_f32 v209, v209, v91, v92
    v_max3_f32 v209, v209, v93, v94
    v_fmamk_f32 v78, v78, 0x3dd53b95, v208
    v_exp_f32 v77, v77
    v_fmamk_f32 v79, v79, 0x3dd53b95, v208
    s_waitcnt lgkmcnt(5)
    s_add_u32 s38, s39, 3072
    buffer_store_dwordx4 v[216:219], v242, s[24:27], s38 offen offset:256 nt
    v_mul_f32 v158, v243, v158
    v_mul_f32 v159, v243, v159
    v_cvt_pk_bf16_f32 v156, v156, v157
    v_cvt_pk_bf16_f32 v157, v158, v159
    s_waitcnt lgkmcnt(2)
    v_mfma_f32_32x32x16_bf16 v[96:111], v[236:239], v[44:47], v[96:111]
    ds_read_b128 v[232:235], v247 offset:16384
    v_max_f32 v209, v209, v95
    v_mul_f32 v209, s32, v209
    v_exp_f32 v78, v78
    v_exp_f32 v79, v79
    s_waitcnt lgkmcnt(2)
    v_mfma_f32_32x32x16_bf16 v[96:111], v[224:227], v[48:51], v[96:111]
    ds_read_b128 v[236:239], v248 offset:16384
    v_fmamk_f32 v80, v80, 0x3dd53b95, v209
    v_fmamk_f32 v81, v81, 0x3dd53b95, v209
    v_exp_f32 v80, v80
    s_waitcnt lgkmcnt(2)
    v_mfma_f32_32x32x16_bf16 v[96:111], v[228:231], v[52:55], v[96:111]
    ds_read_b128 v[224:227], v245 offset:4096
    v_fmamk_f32 v82, v82, 0x3dd53b95, v209
    v_exp_f32 v81, v81
    v_fmamk_f32 v83, v83, 0x3dd53b95, v209
    s_waitcnt lgkmcnt(2)
    v_mfma_f32_32x32x16_bf16 v[96:111], v[232:235], v[56:59], v[96:111]
    ds_read_b128 v[228:231], v246 offset:4096
    v_exp_f32 v82, v82
    v_fmamk_f32 v84, v84, 0x3dd53b95, v209
    s_waitcnt lgkmcnt(2)
    v_mfma_f32_32x32x16_bf16 v[96:111], v[236:239], v[60:63], v[96:111]
    ds_read_b128 v[232:235], v247 offset:4096
    v_exp_f32 v83, v83
    v_fmamk_f32 v85, v85, 0x3dd53b95, v209
    v_exp_f32 v84, v84
    s_waitcnt lgkmcnt(2)
    v_mfma_f32_32x32x16_bf16 v[112:127], v[224:227], v[16:19], 0
    ds_read_b128 v[236:239], v248 offset:4096
    v_fmamk_f32 v86, v86, 0x3dd53b95, v209
    v_exp_f32 v85, v85
    v_fmamk_f32 v87, v87, 0x3dd53b95, v209
    s_waitcnt lgkmcnt(2)
    v_mfma_f32_32x32x16_bf16 v[112:127], v[228:231], v[20:23], v[112:127]
    ds_read_b128 v[224:227], v245 offset:12288
    v_exp_f32 v86, v86
    v_fmamk_f32 v88, v88, 0x3dd53b95, v209
    ds_read_b128 v[216:219], v241 offset:2048
    s_waitcnt lgkmcnt(3)
    v_mfma_f32_32x32x16_bf16 v[112:127], v[232:235], v[24:27], v[112:127]
    ds_read_b128 v[228:231], v246 offset:12288
    v_exp_f32 v87, v87
    v_fmamk_f32 v89, v89, 0x3dd53b95, v209
    v_exp_f32 v88, v88
    s_waitcnt lgkmcnt(3)
    v_mfma_f32_32x32x16_bf16 v[112:127], v[236:239], v[28:31], v[112:127]
    ds_read_b128 v[232:235], v247 offset:12288
    v_fmamk_f32 v90, v90, 0x3dd53b95, v209
    v_exp_f32 v89, v89
    v_fmamk_f32 v91, v91, 0x3dd53b95, v209
    s_waitcnt lgkmcnt(3)
    v_mfma_f32_32x32x16_bf16 v[112:127], v[224:227], v[32:35], v[112:127]
    ds_read_b128 v[236:239], v248 offset:12288
    v_max3_f32 v210, v96, v97, v98
    v_max3_f32 v210, v210, v99, v100
    v_max3_f32 v210, v210, v101, v102
    v_exp_f32 v90, v90
    v_fmamk_f32 v92, v92, 0x3dd53b95, v209
    s_waitcnt lgkmcnt(2)
    v_mfma_f32_32x32x16_bf16 v[112:127], v[228:231], v[36:39], v[112:127]
    ds_read_b128 v[224:227], v245 offset:20480
    v_max3_f32 v210, v210, v103, v104
    v_max3_f32 v210, v210, v105, v106
    v_exp_f32 v91, v91
    v_fmamk_f32 v93, v93, 0x3dd53b95, v209
    v_exp_f32 v92, v92
    s_waitcnt lgkmcnt(2)
    v_mfma_f32_32x32x16_bf16 v[112:127], v[232:235], v[40:43], v[112:127]
    ds_read_b128 v[228:231], v246 offset:20480
    v_max3_f32 v210, v210, v107, v108
    v_max3_f32 v210, v210, v109, v110
    v_fmamk_f32 v94, v94, 0x3dd53b95, v209
    v_exp_f32 v93, v93
    v_fmamk_f32 v95, v95, 0x3dd53b95, v209
    s_waitcnt lgkmcnt(5)
    s_add_u32 s38, s39, 6144
    buffer_store_dwordx4 v[216:219], v242, s[24:27], s38 offen offset:256 nt
    s_waitcnt lgkmcnt(2)
    v_mfma_f32_32x32x16_bf16 v[112:127], v[236:239], v[44:47], v[112:127]
    ds_read_b128 v[232:235], v247 offset:20480
    v_max_f32 v210, v210, v111
    v_mul_f32 v210, s32, v210
    v_exp_f32 v94, v94
    v_exp_f32 v95, v95
    s_waitcnt lgkmcnt(2)
    v_mfma_f32_32x32x16_bf16 v[112:127], v[224:227], v[48:51], v[112:127]
    ds_read_b128 v[236:239], v248 offset:20480
    v_fmamk_f32 v96, v96, 0x3dd53b95, v210
    v_fmamk_f32 v97, v97, 0x3dd53b95, v210
    v_exp_f32 v96, v96
    s_waitcnt lgkmcnt(2)
    v_mfma_f32_32x32x16_bf16 v[112:127], v[228:231], v[52:55], v[112:127]
    s_waitcnt vmcnt(2)
    s_barrier
    v_add_u32 v245, 49152, v249
    v_xor_b32 v246, 32, v245
    v_xor_b32 v247, 64, v245
    v_xor_b32 v248, 96, v245
    ds_read_b128 v[224:227], v245 offset:0
    s_add_u32 m0, s28, 73728
    s_add_u32 s31, s30, 73728
    buffer_load_dwordx4 v244, s[16:19], s31 offen offset:0 nt lds
    v_fmamk_f32 v98, v98, 0x3dd53b95, v210
    v_exp_f32 v97, v97
    v_fmamk_f32 v99, v99, 0x3dd53b95, v210
    s_waitcnt lgkmcnt(2)
    v_mfma_f32_32x32x16_bf16 v[112:127], v[232:235], v[56:59], v[112:127]
    ds_read_b128 v[228:231], v246 offset:0
    s_add_u32 m0, s28, 81792
    s_add_u32 s31, s30, 73728
    buffer_load_dwordx4 v244, s[16:19], s31 offen offset:128 nt lds
    v_exp_f32 v98, v98
    v_fmamk_f32 v100, v100, 0x3dd53b95, v210
    s_waitcnt lgkmcnt(2)
    v_mfma_f32_32x32x16_bf16 v[112:127], v[236:239], v[60:63], v[112:127]
    ds_read_b128 v[232:235], v247 offset:0
    s_add_u32 m0, s28, 89856
    s_add_u32 s31, s30, 73728
    buffer_load_dwordx4 v244, s[16:19], s31 offen offset:256 nt lds
    v_exp_f32 v99, v99
    v_fmamk_f32 v101, v101, 0x3dd53b95, v210
    v_exp_f32 v100, v100
    s_waitcnt lgkmcnt(2)
    v_mfma_f32_32x32x16_bf16 v[0:15], v[224:227], v[16:19], 0
    ds_read_b128 v[236:239], v248 offset:0
    v_fmamk_f32 v102, v102, 0x3dd53b95, v210
    v_exp_f32 v101, v101
    v_fmamk_f32 v103, v103, 0x3dd53b95, v210
    s_waitcnt lgkmcnt(2)
    v_mfma_f32_32x32x16_bf16 v[0:15], v[228:231], v[20:23], v[0:15]
    ds_read_b128 v[224:227], v245 offset:8192
    v_exp_f32 v102, v102
    v_fmamk_f32 v104, v104, 0x3dd53b95, v210
    ds_read_b128 v[216:219], v241 offset:3072
    s_waitcnt lgkmcnt(3)
    v_mfma_f32_32x32x16_bf16 v[0:15], v[232:235], v[24:27], v[0:15]
    ds_read_b128 v[228:231], v246 offset:8192
    v_exp_f32 v103, v103
    v_fmamk_f32 v105, v105, 0x3dd53b95, v210
    v_exp_f32 v104, v104
    ds_write_b64 v240, v[128:129]
    s_waitcnt lgkmcnt(4)
    v_mfma_f32_32x32x16_bf16 v[0:15], v[236:239], v[28:31], v[0:15]
    ds_read_b128 v[232:235], v247 offset:8192
    v_fmamk_f32 v106, v106, 0x3dd53b95, v210
    v_exp_f32 v105, v105
    v_fmamk_f32 v107, v107, 0x3dd53b95, v210
    v_xor_b32 v254, 16, v240
    ds_write_b64 v254, v[132:133]
    s_waitcnt lgkmcnt(5)
    v_mfma_f32_32x32x16_bf16 v[0:15], v[224:227], v[32:35], v[0:15]
    ds_read_b128 v[236:239], v248 offset:8192
    v_max3_f32 v211, v112, v113, v114
    v_max3_f32 v211, v211, v115, v116
    v_max3_f32 v211, v211, v117, v118
    v_exp_f32 v106, v106
    v_fmamk_f32 v108, v108, 0x3dd53b95, v210
    v_xor_b32 v254, 32, v240
    ds_write_b64 v254, v[136:137]
    s_waitcnt lgkmcnt(5)
    v_mfma_f32_32x32x16_bf16 v[0:15], v[228:231], v[36:39], v[0:15]
    ds_read_b128 v[224:227], v245 offset:16384
    v_max3_f32 v211, v211, v119, v120
    v_max3_f32 v211, v211, v121, v122
    v_exp_f32 v107, v107
    v_fmamk_f32 v109, v109, 0x3dd53b95, v210
    v_exp_f32 v108, v108
    v_xor_b32 v254, 48, v240
    ds_write_b64 v254, v[140:141]
    s_waitcnt lgkmcnt(5)
    v_mfma_f32_32x32x16_bf16 v[0:15], v[232:235], v[40:43], v[0:15]
    ds_read_b128 v[228:231], v246 offset:16384
    v_max3_f32 v211, v211, v123, v124
    v_max3_f32 v211, v211, v125, v126
    v_fmamk_f32 v110, v110, 0x3dd53b95, v210
    v_exp_f32 v109, v109
    v_fmamk_f32 v111, v111, 0x3dd53b95, v210
    s_waitcnt lgkmcnt(9)
    s_add_u32 s38, s39, 9216
    buffer_store_dwordx4 v[216:219], v242, s[24:27], s38 offen offset:256 nt
    v_xor_b32 v254, 64, v240
    ds_write_b64 v254, v[144:145]
    s_waitcnt lgkmcnt(5)
    v_mfma_f32_32x32x16_bf16 v[0:15], v[236:239], v[44:47], v[0:15]
    ds_read_b128 v[232:235], v247 offset:16384
    v_max_f32 v211, v211, v127
    v_mul_f32 v211, s32, v211
    v_exp_f32 v110, v110
    v_exp_f32 v111, v111
    v_xor_b32 v254, 80, v240
    ds_write_b64 v254, v[148:149]
    s_waitcnt lgkmcnt(5)
    v_mfma_f32_32x32x16_bf16 v[0:15], v[224:227], v[48:51], v[0:15]
    ds_read_b128 v[236:239], v248 offset:16384
    v_fmamk_f32 v112, v112, 0x3dd53b95, v211
    v_fmamk_f32 v113, v113, 0x3dd53b95, v211
    v_exp_f32 v112, v112
    v_xor_b32 v254, 96, v240
    ds_write_b64 v254, v[152:153]
    s_waitcnt lgkmcnt(5)
    v_mfma_f32_32x32x16_bf16 v[0:15], v[228:231], v[52:55], v[0:15]
    ds_read_b128 v[224:227], v245 offset:4096
    v_fmamk_f32 v114, v114, 0x3dd53b95, v211
    v_exp_f32 v113, v113
    v_fmamk_f32 v115, v115, 0x3dd53b95, v211
    v_xor_b32 v254, 112, v240
    ds_write_b64 v254, v[156:157]
    s_waitcnt lgkmcnt(5)
    v_mfma_f32_32x32x16_bf16 v[0:15], v[232:235], v[56:59], v[0:15]
    ds_read_b128 v[228:231], v246 offset:4096
    v_exp_f32 v114, v114
    v_fmamk_f32 v116, v116, 0x3dd53b95, v211
    s_waitcnt lgkmcnt(4)
    v_mfma_f32_32x32x16_bf16 v[0:15], v[236:239], v[60:63], v[0:15]
    ds_read_b128 v[232:235], v247 offset:4096
    v_exp_f32 v115, v115
    v_fmamk_f32 v117, v117, 0x3dd53b95, v211
    v_exp_f32 v116, v116
    s_waitcnt lgkmcnt(3)
    v_mfma_f32_32x32x16_bf16 v[128:143], v[224:227], v[16:19], 0
    ds_read_b128 v[236:239], v248 offset:4096
    v_fmamk_f32 v118, v118, 0x3dd53b95, v211
    v_exp_f32 v117, v117
    v_fmamk_f32 v119, v119, 0x3dd53b95, v211
    s_waitcnt lgkmcnt(2)
    v_mfma_f32_32x32x16_bf16 v[128:143], v[228:231], v[20:23], v[128:143]
    ds_read_b128 v[224:227], v245 offset:12288
    v_exp_f32 v118, v118
    v_fmamk_f32 v120, v120, 0x3dd53b95, v211
    s_waitcnt lgkmcnt(2)
    v_mfma_f32_32x32x16_bf16 v[128:143], v[232:235], v[24:27], v[128:143]
    ds_read_b128 v[228:231], v246 offset:12288
    v_exp_f32 v119, v119
    v_fmamk_f32 v121, v121, 0x3dd53b95, v211
    v_exp_f32 v120, v120
    s_waitcnt lgkmcnt(2)
    v_mfma_f32_32x32x16_bf16 v[128:143], v[236:239], v[28:31], v[128:143]
    ds_read_b128 v[232:235], v247 offset:12288
    v_fmamk_f32 v122, v122, 0x3dd53b95, v211
    v_exp_f32 v121, v121
    v_fmamk_f32 v123, v123, 0x3dd53b95, v211
    s_waitcnt lgkmcnt(2)
    v_mfma_f32_32x32x16_bf16 v[128:143], v[224:227], v[32:35], v[128:143]
    ds_read_b128 v[236:239], v248 offset:12288
    v_max3_f32 v212, v0, v1, v2
    v_max3_f32 v212, v212, v3, v4
    v_max3_f32 v212, v212, v5, v6
    v_exp_f32 v122, v122
    v_fmamk_f32 v124, v124, 0x3dd53b95, v211
    s_waitcnt lgkmcnt(2)
    v_mfma_f32_32x32x16_bf16 v[128:143], v[228:231], v[36:39], v[128:143]
    ds_read_b128 v[224:227], v245 offset:20480
    v_max3_f32 v212, v212, v7, v8
    v_max3_f32 v212, v212, v9, v10
    v_exp_f32 v123, v123
    v_fmamk_f32 v125, v125, 0x3dd53b95, v211
    v_exp_f32 v124, v124
    s_waitcnt lgkmcnt(2)
    v_mfma_f32_32x32x16_bf16 v[128:143], v[232:235], v[40:43], v[128:143]
    ds_read_b128 v[228:231], v246 offset:20480
    v_max3_f32 v212, v212, v11, v12
    v_max3_f32 v212, v212, v13, v14
    v_fmamk_f32 v126, v126, 0x3dd53b95, v211
    v_exp_f32 v125, v125
    v_fmamk_f32 v127, v127, 0x3dd53b95, v211
    s_waitcnt lgkmcnt(2)
    v_mfma_f32_32x32x16_bf16 v[128:143], v[236:239], v[44:47], v[128:143]
    ds_read_b128 v[232:235], v247 offset:20480
    v_max_f32 v212, v212, v15
    v_mul_f32 v212, s32, v212
    v_exp_f32 v126, v126
    v_exp_f32 v127, v127
    s_waitcnt lgkmcnt(2)
    v_mfma_f32_32x32x16_bf16 v[128:143], v[224:227], v[48:51], v[128:143]
    ds_read_b128 v[236:239], v248 offset:20480
    v_fmamk_f32 v0, v0, 0x3dd53b95, v212
    v_fmamk_f32 v1, v1, 0x3dd53b95, v212
    v_exp_f32 v0, v0
    s_waitcnt lgkmcnt(2)
    v_mfma_f32_32x32x16_bf16 v[128:143], v[228:231], v[52:55], v[128:143]
    s_waitcnt vmcnt(1)
    s_barrier
    v_add_u32 v245, 73728, v249
    v_xor_b32 v246, 32, v245
    v_xor_b32 v247, 64, v245
    v_xor_b32 v248, 96, v245
    ds_read_b128 v[224:227], v245 offset:0
    s_add_u32 m0, s28, 0
    s_add_u32 s31, s30, 0
    buffer_load_dwordx4 v244, s[20:23], s31 offen offset:0 nt lds
    v_fmamk_f32 v2, v2, 0x3dd53b95, v212
    v_exp_f32 v1, v1
    v_fmamk_f32 v3, v3, 0x3dd53b95, v212
    s_waitcnt lgkmcnt(2)
    v_mfma_f32_32x32x16_bf16 v[128:143], v[232:235], v[56:59], v[128:143]
    ds_read_b128 v[228:231], v246 offset:0
    s_add_u32 m0, s28, 8064
    s_add_u32 s31, s30, 0
    buffer_load_dwordx4 v244, s[20:23], s31 offen offset:128 nt lds
    v_exp_f32 v2, v2
    v_fmamk_f32 v4, v4, 0x3dd53b95, v212
    s_waitcnt lgkmcnt(2)
    v_mfma_f32_32x32x16_bf16 v[128:143], v[236:239], v[60:63], v[128:143]
    ds_read_b128 v[232:235], v247 offset:0
    s_add_u32 m0, s28, 16128
    s_add_u32 s31, s30, 0
    buffer_load_dwordx4 v244, s[20:23], s31 offen offset:256 nt lds
    v_exp_f32 v3, v3
    v_fmamk_f32 v5, v5, 0x3dd53b95, v212
    v_exp_f32 v4, v4
    s_waitcnt lgkmcnt(2)
    v_mfma_f32_32x32x16_bf16 v[144:159], v[224:227], v[16:19], 0
    ds_read_b128 v[236:239], v248 offset:0
    v_fmamk_f32 v6, v6, 0x3dd53b95, v212
    v_exp_f32 v5, v5
    v_fmamk_f32 v7, v7, 0x3dd53b95, v212
    s_waitcnt lgkmcnt(2)
    v_mfma_f32_32x32x16_bf16 v[144:159], v[228:231], v[20:23], v[144:159]
    ds_read_b128 v[224:227], v245 offset:8192
    v_exp_f32 v6, v6
    v_fmamk_f32 v8, v8, 0x3dd53b95, v212
    s_waitcnt lgkmcnt(2)
    v_mfma_f32_32x32x16_bf16 v[144:159], v[232:235], v[24:27], v[144:159]
    ds_read_b128 v[228:231], v246 offset:8192
    v_exp_f32 v7, v7
    v_fmamk_f32 v9, v9, 0x3dd53b95, v212
    v_exp_f32 v8, v8
    s_waitcnt lgkmcnt(2)
    v_mfma_f32_32x32x16_bf16 v[144:159], v[236:239], v[28:31], v[144:159]
    ds_read_b128 v[232:235], v247 offset:8192
    v_fmamk_f32 v10, v10, 0x3dd53b95, v212
    v_exp_f32 v9, v9
    v_fmamk_f32 v11, v11, 0x3dd53b95, v212
    s_waitcnt lgkmcnt(2)
    v_mfma_f32_32x32x16_bf16 v[144:159], v[224:227], v[32:35], v[144:159]
    ds_read_b128 v[236:239], v248 offset:8192
    v_max3_f32 v213, v128, v129, v130
    v_max3_f32 v213, v213, v131, v132
    v_max3_f32 v213, v213, v133, v134
    v_exp_f32 v10, v10
    v_fmamk_f32 v12, v12, 0x3dd53b95, v212
    s_waitcnt lgkmcnt(2)
    v_mfma_f32_32x32x16_bf16 v[144:159], v[228:231], v[36:39], v[144:159]
    ds_read_b128 v[224:227], v245 offset:16384
    v_max3_f32 v213, v213, v135, v136
    v_max3_f32 v213, v213, v137, v138
    v_exp_f32 v11, v11
    v_fmamk_f32 v13, v13, 0x3dd53b95, v212
    v_exp_f32 v12, v12
    s_waitcnt lgkmcnt(2)
    v_mfma_f32_32x32x16_bf16 v[144:159], v[232:235], v[40:43], v[144:159]
    ds_read_b128 v[228:231], v246 offset:16384
    v_max3_f32 v213, v213, v139, v140
    v_max3_f32 v213, v213, v141, v142
    v_fmamk_f32 v14, v14, 0x3dd53b95, v212
    v_exp_f32 v13, v13
    v_fmamk_f32 v15, v15, 0x3dd53b95, v212
    s_waitcnt lgkmcnt(2)
    v_mfma_f32_32x32x16_bf16 v[144:159], v[236:239], v[44:47], v[144:159]
    ds_read_b128 v[232:235], v247 offset:16384
    v_max_f32 v213, v213, v143
    v_mul_f32 v213, s32, v213
    v_exp_f32 v14, v14
    v_exp_f32 v15, v15
    s_waitcnt lgkmcnt(2)
    v_mfma_f32_32x32x16_bf16 v[144:159], v[224:227], v[48:51], v[144:159]
    ds_read_b128 v[236:239], v248 offset:16384
    v_fmamk_f32 v128, v128, 0x3dd53b95, v213
    v_fmamk_f32 v129, v129, 0x3dd53b95, v213
    v_exp_f32 v128, v128
    s_waitcnt lgkmcnt(2)
    v_mfma_f32_32x32x16_bf16 v[144:159], v[228:231], v[52:55], v[144:159]
    ds_read_b128 v[224:227], v245 offset:4096
    v_fmamk_f32 v130, v130, 0x3dd53b95, v213
    v_exp_f32 v129, v129
    v_fmamk_f32 v131, v131, 0x3dd53b95, v213
    s_waitcnt lgkmcnt(2)
    v_mfma_f32_32x32x16_bf16 v[144:159], v[232:235], v[56:59], v[144:159]
    ds_read_b128 v[228:231], v246 offset:4096
    v_exp_f32 v130, v130
    v_fmamk_f32 v132, v132, 0x3dd53b95, v213
    s_waitcnt lgkmcnt(2)
    v_mfma_f32_32x32x16_bf16 v[144:159], v[236:239], v[60:63], v[144:159]
    ds_read_b128 v[232:235], v247 offset:4096
    v_exp_f32 v131, v131
    v_fmamk_f32 v133, v133, 0x3dd53b95, v213
    v_exp_f32 v132, v132
    s_waitcnt lgkmcnt(2)
    v_mfma_f32_32x32x16_bf16 v[160:175], v[224:227], v[16:19], 0
    ds_read_b128 v[236:239], v248 offset:4096
    v_fmamk_f32 v134, v134, 0x3dd53b95, v213
    v_exp_f32 v133, v133
    v_fmamk_f32 v135, v135, 0x3dd53b95, v213
    s_waitcnt lgkmcnt(2)
    v_mfma_f32_32x32x16_bf16 v[160:175], v[228:231], v[20:23], v[160:175]
    ds_read_b128 v[224:227], v245 offset:12288
    v_exp_f32 v134, v134
    v_fmamk_f32 v136, v136, 0x3dd53b95, v213
    s_waitcnt lgkmcnt(2)
    v_mfma_f32_32x32x16_bf16 v[160:175], v[232:235], v[24:27], v[160:175]
    ds_read_b128 v[228:231], v246 offset:12288
    v_exp_f32 v135, v135
    v_fmamk_f32 v137, v137, 0x3dd53b95, v213
    v_exp_f32 v136, v136
    s_waitcnt lgkmcnt(2)
    v_mfma_f32_32x32x16_bf16 v[160:175], v[236:239], v[28:31], v[160:175]
    ds_read_b128 v[232:235], v247 offset:12288
    v_fmamk_f32 v138, v138, 0x3dd53b95, v213
    v_exp_f32 v137, v137
    v_fmamk_f32 v139, v139, 0x3dd53b95, v213
    s_waitcnt lgkmcnt(2)
    v_mfma_f32_32x32x16_bf16 v[160:175], v[224:227], v[32:35], v[160:175]
    ds_read_b128 v[236:239], v248 offset:12288
    v_max3_f32 v214, v144, v145, v146
    v_max3_f32 v214, v214, v147, v148
    v_max3_f32 v214, v214, v149, v150
    v_exp_f32 v138, v138
    v_fmamk_f32 v140, v140, 0x3dd53b95, v213
    s_waitcnt lgkmcnt(2)
    v_mfma_f32_32x32x16_bf16 v[160:175], v[228:231], v[36:39], v[160:175]
    ds_read_b128 v[224:227], v245 offset:20480
    v_max3_f32 v214, v214, v151, v152
    v_max3_f32 v214, v214, v153, v154
    v_exp_f32 v139, v139
    v_fmamk_f32 v141, v141, 0x3dd53b95, v213
    v_exp_f32 v140, v140
    s_waitcnt lgkmcnt(2)
    v_mfma_f32_32x32x16_bf16 v[160:175], v[232:235], v[40:43], v[160:175]
    ds_read_b128 v[228:231], v246 offset:20480
    v_max3_f32 v214, v214, v155, v156
    v_max3_f32 v214, v214, v157, v158
    v_fmamk_f32 v142, v142, 0x3dd53b95, v213
    v_exp_f32 v141, v141
    v_fmamk_f32 v143, v143, 0x3dd53b95, v213
    s_waitcnt lgkmcnt(2)
    v_mfma_f32_32x32x16_bf16 v[160:175], v[236:239], v[44:47], v[160:175]
    ds_read_b128 v[232:235], v247 offset:20480
    v_max_f32 v214, v214, v159
    v_mul_f32 v214, s32, v214
    v_exp_f32 v142, v142
    v_exp_f32 v143, v143
    s_waitcnt lgkmcnt(2)
    v_mfma_f32_32x32x16_bf16 v[160:175], v[224:227], v[48:51], v[160:175]
    ds_read_b128 v[236:239], v248 offset:20480
    s_waitcnt lgkmcnt(2)
    v_mfma_f32_32x32x16_bf16 v[160:175], v[228:231], v[52:55], v[160:175]
    s_waitcnt vmcnt(0)
    s_barrier
    v_add_u32 v245, 0, v251
    v_xor_b32 v246, 16, v245
    v_xor_b32 v247, 64, v245
    v_xor_b32 v248, 0x50, v245
    ds_read_b64_tr_b16 v[224:225], v245 offset:0
    ds_read_b64_tr_b16 v[226:227], v246 offset:1024
    s_add_u32 m0, s28, 24576
    s_add_u32 s31, s30, 24576
    buffer_load_dwordx4 v244, s[20:23], s31 offen offset:0 nt lds
    s_waitcnt lgkmcnt(3)
    v_mfma_f32_32x32x16_bf16 v[160:175], v[232:235], v[56:59], v[160:175]
    ds_read_b64_tr_b16 v[228:229], v247 offset:0
    ds_read_b64_tr_b16 v[230:231], v248 offset:1024
    s_add_u32 m0, s28, 32640
    s_add_u32 s31, s30, 24576
    buffer_load_dwordx4 v244, s[20:23], s31 offen offset:128 nt lds
    s_waitcnt lgkmcnt(4)
    v_mfma_f32_32x32x16_bf16 v[160:175], v[236:239], v[60:63], v[160:175]
    ds_read_b64_tr_b16 v[232:233], v245 offset:8192
    ds_read_b64_tr_b16 v[234:235], v246 offset:9216
    s_add_u32 m0, s28, 40704
    s_add_u32 s31, s30, 24576
    buffer_load_dwordx4 v244, s[20:23], s31 offen offset:256 nt lds
    s_nop 7
    s_nop 3
    v_max3_f32 v215, v160, v161, v162
    v_max3_f32 v215, v215, v163, v164
    v_max3_f32 v215, v215, v165, v166
    v_max3_f32 v215, v215, v167, v168
    v_max3_f32 v215, v215, v169, v170
    v_max3_f32 v215, v215, v171, v172
    v_max3_f32 v215, v215, v173, v174
    v_max_f32 v215, v215, v175
    v_mul_f32 v215, s32, v215
    v_min3_f32 v250, v208, v209, v210
    v_min3_f32 v250, v250, v211, v212
    v_min3_f32 v250, v250, v213, v214
    v_min_f32 v250, v250, v215
    v_mov_b32 v254, v250
    s_nop 1
    v_permlane32_swap_b32 v250, v254
    s_nop 1
    v_min_f32 v250, v250, v254
    v_sub_f32 v254, v250, v208
    v_exp_f32 v254, v254
    v_sub_f32 v213, v250, v213
    v_mul_f32 v64, v254, v64
    v_mul_f32 v65, v254, v65
    v_mul_f32 v66, v254, v66
    v_mul_f32 v67, v254, v67
    v_mul_f32 v68, v254, v68
    v_mul_f32 v69, v254, v69
    v_mul_f32 v70, v254, v70
    v_mul_f32 v71, v254, v71
    v_mov_b32 v252, v64
    v_mov_b32 v253, v65
    v_cvt_pk_bf16_f32 v64, v64, v65
    v_add_f32 v252, v252, v66
    v_add_f32 v253, v253, v67
    v_cvt_pk_bf16_f32 v65, v66, v67
    v_add_f32 v252, v252, v68
    v_add_f32 v253, v253, v69
    v_cvt_pk_bf16_f32 v66, v68, v69
    v_add_f32 v252, v252, v70
    v_add_f32 v253, v253, v71
    v_cvt_pk_bf16_f32 v67, v70, v71
    v_exp_f32 v255, v213
    v_sub_f32 v68, v250, v209
    v_sub_f32 v69, v250, v210
    v_sub_f32 v70, v250, v211
    v_sub_f32 v71, v250, v212
    v_exp_f32 v68, v68
    v_exp_f32 v69, v69
    v_exp_f32 v70, v70
    v_exp_f32 v71, v71
    s_nop 0
    s_waitcnt lgkmcnt(4)
    v_mfma_f32_32x32x16_bf16 v[16:31], v[224:227], v[64:67], 0
    ds_read_b64_tr_b16 v[236:237], v247 offset:8192
    ds_read_b64_tr_b16 v[238:239], v248 offset:9216
    v_mul_f32 v72, v254, v72
    v_mul_f32 v73, v254, v73
    v_mul_f32 v74, v254, v74
    v_mul_f32 v75, v254, v75
    v_fmamk_f32 v144, v144, 0x3dd53b95, v250
    s_waitcnt lgkmcnt(4)
    v_mfma_f32_32x32x16_bf16 v[32:47], v[228:231], v[64:67], 0
    ds_read_b64_tr_b16 v[224:225], v245 offset:16384
    ds_read_b64_tr_b16 v[226:227], v246 offset:17408
    v_mul_f32 v76, v254, v76
    v_mul_f32 v77, v254, v77
    v_mul_f32 v78, v254, v78
    v_mul_f32 v79, v254, v79
    v_fmamk_f32 v145, v145, 0x3dd53b95, v250
    s_waitcnt lgkmcnt(4)
    v_mfma_f32_32x32x16_bf16 v[48:63], v[232:235], v[64:67], 0
    ds_read_b64_tr_b16 v[228:229], v247 offset:16384
    ds_read_b64_tr_b16 v[230:231], v248 offset:17408
    v_add_f32 v252, v252, v72
    v_add_f32 v253, v253, v73
    v_cvt_pk_bf16_f32 v72, v72, v73
    v_add_f32 v252, v252, v74
    s_waitcnt lgkmcnt(4)
    v_mfma_f32_32x32x16_bf16 v[176:191], v[236:239], v[64:67], 0
    ds_read_b64_tr_b16 v[232:233], v245 offset:2048
    ds_read_b64_tr_b16 v[234:235], v246 offset:3072
    v_add_f32 v253, v253, v75
    v_cvt_pk_bf16_f32 v73, v74, v75
    v_add_f32 v252, v252, v76
    v_add_f32 v253, v253, v77
    v_exp_f32 v144, v144
    s_waitcnt lgkmcnt(4)
    v_mfma_f32_32x32x16_bf16 v[192:207], v[224:227], v[64:67], 0
    ds_read_b64_tr_b16 v[236:237], v247 offset:2048
    ds_read_b64_tr_b16 v[238:239], v248 offset:3072
    v_cvt_pk_bf16_f32 v74, v76, v77
    v_add_f32 v252, v252, v78
    v_add_f32 v253, v253, v79
    v_cvt_pk_bf16_f32 v75, v78, v79
    v_fmamk_f32 v146, v146, 0x3dd53b95, v250
    s_waitcnt lgkmcnt(4)
    v_mfma_f32_32x32x16_bf16 v[208:223], v[228:231], v[64:67], 0
    ds_read_b64_tr_b16 v[224:225], v245 offset:10240
    ds_read_b64_tr_b16 v[226:227], v246 offset:11264
    s_waitcnt lgkmcnt(4)
    v_mfma_f32_32x32x16_bf16 v[16:31], v[232:235], v[72:75], v[16:31]
    ds_read_b64_tr_b16 v[228:229], v247 offset:10240
    ds_read_b64_tr_b16 v[230:231], v248 offset:11264
    v_mul_f32 v80, v68, v80
    v_mul_f32 v81, v68, v81
    v_mul_f32 v82, v68, v82
    v_mul_f32 v83, v68, v83
    v_exp_f32 v145, v145
    v_fmamk_f32 v160, v160, 0x3dd53b95, v250
    s_waitcnt lgkmcnt(4)
    v_mfma_f32_32x32x16_bf16 v[32:47], v[236:239], v[72:75], v[32:47]
    ds_read_b64_tr_b16 v[232:233], v245 offset:18432
    ds_read_b64_tr_b16 v[234:235], v246 offset:19456
    v_mul_f32 v84, v68, v84
    v_mul_f32 v85, v68, v85
    v_mul_f32 v86, v68, v86
    v_mul_f32 v87, v68, v87
    v_fmamk_f32 v147, v147, 0x3dd53b95, v250
    v_fmamk_f32 v161, v161, 0x3dd53b95, v250
    s_waitcnt lgkmcnt(4)
    v_mfma_f32_32x32x16_bf16 v[48:63], v[224:227], v[72:75], v[48:63]
    ds_read_b64_tr_b16 v[236:237], v247 offset:18432
    ds_read_b64_tr_b16 v[238:239], v248 offset:19456
    v_add_f32 v252, v252, v80
    v_add_f32 v253, v253, v81
    v_cvt_pk_bf16_f32 v80, v80, v81
    v_add_f32 v252, v252, v82
    s_waitcnt lgkmcnt(4)
    v_mfma_f32_32x32x16_bf16 v[176:191], v[228:231], v[72:75], v[176:191]
    ds_read_b64_tr_b16 v[224:225], v245 offset:4096
    ds_read_b64_tr_b16 v[226:227], v246 offset:5120
    v_add_f32 v253, v253, v83
    v_cvt_pk_bf16_f32 v81, v82, v83
    v_add_f32 v252, v252, v84
    v_add_f32 v253, v253, v85
    v_exp_f32 v146, v146
    v_exp_f32 v160, v160
    s_waitcnt lgkmcnt(4)
    v_mfma_f32_32x32x16_bf16 v[192:207], v[232:235], v[72:75], v[192:207]
    ds_read_b64_tr_b16 v[228:229], v247 offset:4096
    ds_read_b64_tr_b16 v[230:231], v248 offset:5120
    v_cvt_pk_bf16_f32 v82, v84, v85
    v_add_f32 v252, v252, v86
    v_add_f32 v253, v253, v87
    v_cvt_pk_bf16_f32 v83, v86, v87
    v_fmamk_f32 v148, v148, 0x3dd53b95, v250
    v_fmamk_f32 v162, v162, 0x3dd53b95, v250
    s_waitcnt lgkmcnt(4)
    v_mfma_f32_32x32x16_bf16 v[208:223], v[236:239], v[72:75], v[208:223]
    ds_read_b64_tr_b16 v[232:233], v245 offset:12288
    ds_read_b64_tr_b16 v[234:235], v246 offset:13312
    s_waitcnt lgkmcnt(4)
    v_mfma_f32_32x32x16_bf16 v[16:31], v[224:227], v[80:83], v[16:31]
    ds_read_b64_tr_b16 v[236:237], v247 offset:12288
    ds_read_b64_tr_b16 v[238:239], v248 offset:13312
    v_mul_f32 v88, v68, v88
    v_mul_f32 v89, v68, v89
    v_mul_f32 v90, v68, v90
    v_mul_f32 v91, v68, v91
    v_exp_f32 v147, v147
    v_exp_f32 v161, v161
    s_waitcnt lgkmcnt(4)
    v_mfma_f32_32x32x16_bf16 v[32:47], v[228:231], v[80:83], v[32:47]
    ds_read_b64_tr_b16 v[224:225], v245 offset:20480
    ds_read_b64_tr_b16 v[226:227], v246 offset:21504
    v_mul_f32 v92, v68, v92
    v_mul_f32 v93, v68, v93
    v_mul_f32 v94, v68, v94
    v_mul_f32 v95, v68, v95
    v_fmamk_f32 v149, v149, 0x3dd53b95, v250
    v_fmamk_f32 v163, v163, 0x3dd53b95, v250
    ds_read_b128 v[84:87], v241 offset:4096
    s_waitcnt lgkmcnt(5)
    v_mfma_f32_32x32x16_bf16 v[48:63], v[232:235], v[80:83], v[48:63]
    ds_read_b64_tr_b16 v[228:229], v247 offset:20480
    ds_read_b64_tr_b16 v[230:231], v248 offset:21504
    v_add_f32 v252, v252, v88
    v_add_f32 v253, v253, v89
    v_cvt_pk_bf16_f32 v88, v88, v89
    v_add_f32 v252, v252, v90
    s_waitcnt lgkmcnt(5)
    v_mfma_f32_32x32x16_bf16 v[176:191], v[236:239], v[80:83], v[176:191]
    ds_read_b64_tr_b16 v[232:233], v245 offset:6144
    ds_read_b64_tr_b16 v[234:235], v246 offset:7168
    v_add_f32 v253, v253, v91
    v_cvt_pk_bf16_f32 v89, v90, v91
    v_add_f32 v252, v252, v92
    v_add_f32 v253, v253, v93
    v_exp_f32 v148, v148
    v_exp_f32 v162, v162
    s_waitcnt lgkmcnt(5)
    v_mfma_f32_32x32x16_bf16 v[192:207], v[224:227], v[80:83], v[192:207]
    ds_read_b64_tr_b16 v[236:237], v247 offset:6144
    ds_read_b64_tr_b16 v[238:239], v248 offset:7168
    v_cvt_pk_bf16_f32 v90, v92, v93
    v_add_f32 v252, v252, v94
    v_add_f32 v253, v253, v95
    v_cvt_pk_bf16_f32 v91, v94, v95
    v_fmamk_f32 v150, v150, 0x3dd53b95, v250
    v_fmamk_f32 v164, v164, 0x3dd53b95, v250
    s_waitcnt lgkmcnt(4)
    v_mfma_f32_32x32x16_bf16 v[208:223], v[228:231], v[80:83], v[208:223]
    ds_read_b64_tr_b16 v[224:225], v245 offset:14336
    ds_read_b64_tr_b16 v[226:227], v246 offset:15360
    s_waitcnt lgkmcnt(4)
    v_mfma_f32_32x32x16_bf16 v[16:31], v[232:235], v[88:91], v[16:31]
    ds_read_b64_tr_b16 v[228:229], v247 offset:14336
    ds_read_b64_tr_b16 v[230:231], v248 offset:15360
    v_mul_f32 v96, v69, v96
    v_mul_f32 v97, v69, v97
    v_mul_f32 v98, v69, v98
    v_mul_f32 v99, v69, v99
    v_exp_f32 v149, v149
    v_exp_f32 v163, v163
    s_waitcnt lgkmcnt(10)
    s_add_u32 s38, s39, 0
    buffer_store_dwordx4 v[84:87], v242, s[24:27], s38 offen offset:128 nt
    s_waitcnt lgkmcnt(4)
    v_mfma_f32_32x32x16_bf16 v[32:47], v[236:239], v[88:91], v[32:47]
    ds_read_b64_tr_b16 v[232:233], v245 offset:22528
    ds_read_b64_tr_b16 v[234:235], v246 offset:23552
    v_mul_f32 v100, v69, v100
    v_mul_f32 v101, v69, v101
    v_mul_f32 v102, v69, v102
    v_mul_f32 v103, v69, v103
    v_fmamk_f32 v151, v151, 0x3dd53b95, v250
    s_waitcnt lgkmcnt(4)
    v_mfma_f32_32x32x16_bf16 v[48:63], v[224:227], v[88:91], v[48:63]
    ds_read_b64_tr_b16 v[236:237], v247 offset:22528
    ds_read_b64_tr_b16 v[238:239], v248 offset:23552
    v_add_f32 v252, v252, v96
    v_add_f32 v253, v253, v97
    v_cvt_pk_bf16_f32 v96, v96, v97
    v_add_f32 v252, v252, v98
    v_fmamk_f32 v165, v165, 0x3dd53b95, v250
    s_waitcnt lgkmcnt(4)
    v_mfma_f32_32x32x16_bf16 v[176:191], v[228:231], v[88:91], v[176:191]
    s_waitcnt vmcnt(1)
    s_barrier
    v_add_u32 v245, 24576, v251
    v_xor_b32 v246, 16, v245
    v_xor_b32 v247, 64, v245
    v_xor_b32 v248, 0x50, v245
    ds_read_b64_tr_b16 v[224:225], v245 offset:0
    ds_read_b64_tr_b16 v[226:227], v246 offset:1024
    s_add_u32 m0, s28, 49152
    s_add_u32 s31, s30, 49152
    buffer_load_dwordx4 v244, s[20:23], s31 offen offset:0 nt lds
    v_add_f32 v253, v253, v99
    v_cvt_pk_bf16_f32 v97, v98, v99
    v_add_f32 v252, v252, v100
    v_add_f32 v253, v253, v101
    v_exp_f32 v150, v150
    v_exp_f32 v164, v164
    ds_read_b128 v[84:87], v241 offset:5120
    s_waitcnt lgkmcnt(5)
    v_mfma_f32_32x32x16_bf16 v[192:207], v[232:235], v[88:91], v[192:207]
    ds_read_b64_tr_b16 v[228:229], v247 offset:0
    ds_read_b64_tr_b16 v[230:231], v248 offset:1024
    s_add_u32 m0, s28, 57216
    s_add_u32 s31, s30, 49152
    buffer_load_dwordx4 v244, s[20:23], s31 offen offset:128 nt lds
    v_cvt_pk_bf16_f32 v98, v100, v101
    v_add_f32 v252, v252, v102
    v_add_f32 v253, v253, v103
    v_cvt_pk_bf16_f32 v99, v102, v103
    v_fmamk_f32 v152, v152, 0x3dd53b95, v250
    s_waitcnt lgkmcnt(5)
    v_mfma_f32_32x32x16_bf16 v[208:223], v[236:239], v[88:91], v[208:223]
    ds_read_b64_tr_b16 v[232:233], v245 offset:8192
    ds_read_b64_tr_b16 v[234:235], v246 offset:9216
    s_add_u32 m0, s28, 65280
    s_add_u32 s31, s30, 49152
    buffer_load_dwordx4 v244, s[20:23], s31 offen offset:256 nt lds
    v_fmamk_f32 v166, v166, 0x3dd53b95, v250
    s_waitcnt lgkmcnt(5)
    v_mfma_f32_32x32x16_bf16 v[16:31], v[224:227], v[96:99], v[16:31]
    ds_read_b64_tr_b16 v[236:237], v247 offset:8192
    ds_read_b64_tr_b16 v[238:239], v248 offset:9216
    v_mul_f32 v104, v69, v104
    v_mul_f32 v105, v69, v105
    v_mul_f32 v106, v69, v106
    v_mul_f32 v107, v69, v107
    v_exp_f32 v151, v151
    v_exp_f32 v165, v165
    s_waitcnt lgkmcnt(4)
    v_mfma_f32_32x32x16_bf16 v[32:47], v[228:231], v[96:99], v[32:47]
    ds_read_b64_tr_b16 v[224:225], v245 offset:16384
    ds_read_b64_tr_b16 v[226:227], v246 offset:17408
    v_mul_f32 v108, v69, v108
    v_mul_f32 v109, v69, v109
    v_mul_f32 v110, v69, v110
    v_mul_f32 v111, v69, v111
    v_fmamk_f32 v153, v153, 0x3dd53b95, v250
    s_waitcnt lgkmcnt(4)
    v_mfma_f32_32x32x16_bf16 v[48:63], v[232:235], v[96:99], v[48:63]
    ds_read_b64_tr_b16 v[228:229], v247 offset:16384
    ds_read_b64_tr_b16 v[230:231], v248 offset:17408
    v_add_f32 v252, v252, v104
    v_add_f32 v253, v253, v105
    v_cvt_pk_bf16_f32 v104, v104, v105
    v_add_f32 v252, v252, v106
    v_fmamk_f32 v167, v167, 0x3dd53b95, v250
    s_waitcnt lgkmcnt(10)
    s_add_u32 s38, s39, 3072
    buffer_store_dwordx4 v[84:87], v242, s[24:27], s38 offen offset:128 nt
    s_waitcnt lgkmcnt(4)
    v_mfma_f32_32x32x16_bf16 v[176:191], v[236:239], v[96:99], v[176:191]
    ds_read_b64_tr_b16 v[232:233], v245 offset:2048
    ds_read_b64_tr_b16 v[234:235], v246 offset:3072
    v_add_f32 v253, v253, v107
    v_cvt_pk_bf16_f32 v105, v106, v107
    v_add_f32 v252, v252, v108
    v_add_f32 v253, v253, v109
    v_exp_f32 v152, v152
    v_exp_f32 v166, v166
    s_waitcnt lgkmcnt(4)
    v_mfma_f32_32x32x16_bf16 v[192:207], v[224:227], v[96:99], v[192:207]
    ds_read_b64_tr_b16 v[236:237], v247 offset:2048
    ds_read_b64_tr_b16 v[238:239], v248 offset:3072
    v_cvt_pk_bf16_f32 v106, v108, v109
    v_add_f32 v252, v252, v110
    v_add_f32 v253, v253, v111
    v_cvt_pk_bf16_f32 v107, v110, v111
    v_fmamk_f32 v154, v154, 0x3dd53b95, v250
    s_waitcnt lgkmcnt(4)
    v_mfma_f32_32x32x16_bf16 v[208:223], v[228:231], v[96:99], v[208:223]
    ds_read_b64_tr_b16 v[224:225], v245 offset:10240
    ds_read_b64_tr_b16 v[226:227], v246 offset:11264
    v_fmamk_f32 v168, v168, 0x3dd53b95, v250
    ds_read_b128 v[84:87], v241 offset:6144
    s_waitcnt lgkmcnt(5)
    v_mfma_f32_32x32x16_bf16 v[16:31], v[232:235], v[104:107], v[16:31]
    ds_read_b64_tr_b16 v[228:229], v247 offset:10240
    ds_read_b64_tr_b16 v[230:231], v248 offset:11264
    v_mul_f32 v112, v70, v112
    v_mul_f32 v113, v70, v113
    v_mul_f32 v114, v70, v114
    v_mul_f32 v115, v70, v115
    v_exp_f32 v153, v153
    s_waitcnt lgkmcnt(5)
    v_mfma_f32_32x32x16_bf16 v[32:47], v[236:239], v[104:107], v[32:47]
    ds_read_b64_tr_b16 v[232:233], v245 offset:18432
    ds_read_b64_tr_b16 v[234:235], v246 offset:19456
    v_mul_f32 v116, v70, v116
    v_mul_f32 v117, v70, v117
    v_mul_f32 v118, v70, v118
    v_mul_f32 v119, v70, v119
    v_fmamk_f32 v155, v155, 0x3dd53b95, v250
    v_exp_f32 v167, v167
    s_waitcnt lgkmcnt(5)
    v_mfma_f32_32x32x16_bf16 v[48:63], v[224:227], v[104:107], v[48:63]
    ds_read_b64_tr_b16 v[236:237], v247 offset:18432
    ds_read_b64_tr_b16 v[238:239], v248 offset:19456
    v_add_f32 v252, v252, v112
    v_add_f32 v253, v253, v113
    v_cvt_pk_bf16_f32 v112, v112, v113
    v_add_f32 v252, v252, v114
    v_fmamk_f32 v169, v169, 0x3dd53b95, v250
    s_waitcnt lgkmcnt(4)
    v_mfma_f32_32x32x16_bf16 v[176:191], v[228:231], v[104:107], v[176:191]
    ds_read_b64_tr_b16 v[224:225], v245 offset:4096
    ds_read_b64_tr_b16 v[226:227], v246 offset:5120
    v_add_f32 v253, v253, v115
    v_cvt_pk_bf16_f32 v113, v114, v115
    v_add_f32 v252, v252, v116
    v_add_f32 v253, v253, v117
    v_exp_f32 v154, v154
    s_waitcnt lgkmcnt(4)
    v_mfma_f32_32x32x16_bf16 v[192:207], v[232:235], v[104:107], v[192:207]
    ds_read_b64_tr_b16 v[228:229], v247 offset:4096
    ds_read_b64_tr_b16 v[230:231], v248 offset:5120
    v_cvt_pk_bf16_f32 v114, v116, v117
    v_add_f32 v252, v252, v118
    v_add_f32 v253, v253, v119
    v_cvt_pk_bf16_f32 v115, v118, v119
    v_fmamk_f32 v156, v156, 0x3dd53b95, v250
    v_exp_f32 v168, v168
    s_waitcnt lgkmcnt(10)
    s_add_u32 s38, s39, 6144
    buffer_store_dwordx4 v[84:87], v242, s[24:27], s38 offen offset:128 nt
    s_waitcnt lgkmcnt(4)
    v_mfma_f32_32x32x16_bf16 v[208:223], v[236:239], v[104:107], v[208:223]
    ds_read_b64_tr_b16 v[232:233], v245 offset:12288
    ds_read_b64_tr_b16 v[234:235], v246 offset:13312
    v_fmamk_f32 v170, v170, 0x3dd53b95, v250
    s_waitcnt lgkmcnt(4)
    v_mfma_f32_32x32x16_bf16 v[16:31], v[224:227], v[112:115], v[16:31]
    ds_read_b64_tr_b16 v[236:237], v247 offset:12288
    ds_read_b64_tr_b16 v[238:239], v248 offset:13312
    v_mul_f32 v120, v70, v120
    v_mul_f32 v121, v70, v121
    v_mul_f32 v122, v70, v122
    v_mul_f32 v123, v70, v123
    v_exp_f32 v155, v155
    s_waitcnt lgkmcnt(4)
    v_mfma_f32_32x32x16_bf16 v[32:47], v[228:231], v[112:115], v[32:47]
    ds_read_b64_tr_b16 v[224:225], v245 offset:20480
    ds_read_b64_tr_b16 v[226:227], v246 offset:21504
    v_mul_f32 v124, v70, v124
    v_mul_f32 v125, v70, v125
    v_mul_f32 v126, v70, v126
    v_mul_f32 v127, v70, v127
    v_fmamk_f32 v157, v157, 0x3dd53b95, v250
    v_exp_f32 v169, v169
    ds_read_b128 v[84:87], v241 offset:7168
    s_waitcnt lgkmcnt(5)
    v_mfma_f32_32x32x16_bf16 v[48:63], v[232:235], v[112:115], v[48:63]
    ds_read_b64_tr_b16 v[228:229], v247 offset:20480
    ds_read_b64_tr_b16 v[230:231], v248 offset:21504
    v_add_f32 v252, v252, v120
    v_add_f32 v253, v253, v121
    v_cvt_pk_bf16_f32 v120, v120, v121
    v_add_f32 v252, v252, v122
    v_fmamk_f32 v171, v171, 0x3dd53b95, v250
    s_waitcnt lgkmcnt(5)
    v_mfma_f32_32x32x16_bf16 v[176:191], v[236:239], v[112:115], v[176:191]
    ds_read_b64_tr_b16 v[232:233], v245 offset:6144
    ds_read_b64_tr_b16 v[234:235], v246 offset:7168
    v_add_f32 v253, v253, v123
    v_cvt_pk_bf16_f32 v121, v122, v123
    v_add_f32 v252, v252, v124
    v_add_f32 v253, v253, v125
    v_exp_f32 v156, v156
    s_waitcnt lgkmcnt(5)
    v_mfma_f32_32x32x16_bf16 v[192:207], v[224:227], v[112:115], v[192:207]
    ds_read_b64_tr_b16 v[236:237], v247 offset:6144
    ds_read_b64_tr_b16 v[238:239], v248 offset:7168
    v_cvt_pk_bf16_f32 v122, v124, v125
    v_add_f32 v252, v252, v126
    v_add_f32 v253, v253, v127
    v_cvt_pk_bf16_f32 v123, v126, v127
    v_fmamk_f32 v158, v158, 0x3dd53b95, v250
    v_exp_f32 v170, v170
    s_waitcnt lgkmcnt(4)
    v_mfma_f32_32x32x16_bf16 v[208:223], v[228:231], v[112:115], v[208:223]
    ds_read_b64_tr_b16 v[224:225], v245 offset:14336
    ds_read_b64_tr_b16 v[226:227], v246 offset:15360
    v_fmamk_f32 v172, v172, 0x3dd53b95, v250
    s_waitcnt lgkmcnt(4)
    v_mfma_f32_32x32x16_bf16 v[16:31], v[232:235], v[120:123], v[16:31]
    ds_read_b64_tr_b16 v[228:229], v247 offset:14336
    ds_read_b64_tr_b16 v[230:231], v248 offset:15360
    v_mul_f32 v0, v71, v0
    v_mul_f32 v1, v71, v1
    v_mul_f32 v2, v71, v2
    v_mul_f32 v3, v71, v3
    v_exp_f32 v157, v157
    s_waitcnt lgkmcnt(10)
    s_add_u32 s38, s39, 9216
    buffer_store_dwordx4 v[84:87], v242, s[24:27], s38 offen offset:128 nt
    s_waitcnt lgkmcnt(4)
    v_mfma_f32_32x32x16_bf16 v[32:47], v[236:239], v[120:123], v[32:47]
    ds_read_b64_tr_b16 v[232:233], v245 offset:22528
    ds_read_b64_tr_b16 v[234:235], v246 offset:23552
    v_mul_f32 v4, v71, v4
    v_mul_f32 v5, v71, v5
    v_mul_f32 v6, v71, v6
    v_mul_f32 v7, v71, v7
    v_fmamk_f32 v159, v159, 0x3dd53b95, v250
    v_exp_f32 v171, v171
    s_waitcnt lgkmcnt(4)
    v_mfma_f32_32x32x16_bf16 v[48:63], v[224:227], v[120:123], v[48:63]
    ds_read_b64_tr_b16 v[236:237], v247 offset:22528
    ds_read_b64_tr_b16 v[238:239], v248 offset:23552
    v_add_f32 v252, v252, v0
    v_add_f32 v253, v253, v1
    v_cvt_pk_bf16_f32 v0, v0, v1
    v_add_f32 v252, v252, v2
    s_waitcnt lgkmcnt(4)
    v_mfma_f32_32x32x16_bf16 v[176:191], v[228:231], v[120:123], v[176:191]
    s_waitcnt vmcnt(3)
    s_barrier
    v_add_u32 v245, 49152, v251
    v_xor_b32 v246, 16, v245
    v_xor_b32 v247, 64, v245
    v_xor_b32 v248, 0x50, v245
    ds_read_b64_tr_b16 v[224:225], v245 offset:0
    ds_read_b64_tr_b16 v[226:227], v246 offset:1024
    s_add_u32 m0, s28, 73728
    s_add_u32 s31, s30, 73728
    buffer_load_dwordx4 v244, s[20:23], s31 offen offset:0 nt lds
    v_add_f32 v253, v253, v3
    v_cvt_pk_bf16_f32 v1, v2, v3
    v_add_f32 v252, v252, v4
    v_add_f32 v253, v253, v5
    v_exp_f32 v158, v158
    v_fmamk_f32 v173, v173, 0x3dd53b95, v250
    ds_read_b128 v[84:87], v241 offset:0
    s_waitcnt lgkmcnt(5)
    v_mfma_f32_32x32x16_bf16 v[192:207], v[232:235], v[120:123], v[192:207]
    ds_read_b64_tr_b16 v[228:229], v247 offset:0
    ds_read_b64_tr_b16 v[230:231], v248 offset:1024
    s_add_u32 m0, s28, 81792
    s_add_u32 s31, s30, 73728
    buffer_load_dwordx4 v244, s[20:23], s31 offen offset:128 nt lds
    v_cvt_pk_bf16_f32 v2, v4, v5
    v_add_f32 v252, v252, v6
    v_add_f32 v253, v253, v7
    v_cvt_pk_bf16_f32 v3, v6, v7
    v_exp_f32 v159, v159
    v_exp_f32 v172, v172
    s_waitcnt lgkmcnt(5)
    v_mfma_f32_32x32x16_bf16 v[208:223], v[236:239], v[120:123], v[208:223]
    ds_read_b64_tr_b16 v[232:233], v245 offset:8192
    ds_read_b64_tr_b16 v[234:235], v246 offset:9216
    s_add_u32 m0, s28, 89856
    s_add_u32 s31, s30, 73728
    buffer_load_dwordx4 v244, s[20:23], s31 offen offset:256 nt lds
    s_waitcnt lgkmcnt(5)
    v_mfma_f32_32x32x16_bf16 v[16:31], v[224:227], v[0:3], v[16:31]
    ds_read_b64_tr_b16 v[236:237], v247 offset:8192
    ds_read_b64_tr_b16 v[238:239], v248 offset:9216
    v_mul_f32 v8, v71, v8
    v_mul_f32 v9, v71, v9
    v_mul_f32 v10, v71, v10
    v_mul_f32 v11, v71, v11
    v_fmamk_f32 v174, v174, 0x3dd53b95, v250
    s_waitcnt lgkmcnt(4)
    v_mfma_f32_32x32x16_bf16 v[32:47], v[228:231], v[0:3], v[32:47]
    ds_read_b64_tr_b16 v[224:225], v245 offset:16384
    ds_read_b64_tr_b16 v[226:227], v246 offset:17408
    v_mul_f32 v12, v71, v12
    v_mul_f32 v13, v71, v13
    v_mul_f32 v14, v71, v14
    v_mul_f32 v15, v71, v15
    v_exp_f32 v173, v173
    s_waitcnt lgkmcnt(4)
    v_mfma_f32_32x32x16_bf16 v[48:63], v[232:235], v[0:3], v[48:63]
    ds_read_b64_tr_b16 v[228:229], v247 offset:16384
    ds_read_b64_tr_b16 v[230:231], v248 offset:17408
    v_add_f32 v252, v252, v8
    v_add_f32 v253, v253, v9
    v_cvt_pk_bf16_f32 v8, v8, v9
    v_add_f32 v252, v252, v10
    s_waitcnt lgkmcnt(10)
    s_add_u32 s38, s39, 0
    buffer_store_dwordx4 v[84:87], v242, s[24:27], s38 offen offset:0 nt
    s_waitcnt lgkmcnt(4)
    v_mfma_f32_32x32x16_bf16 v[176:191], v[236:239], v[0:3], v[176:191]
    ds_read_b64_tr_b16 v[232:233], v245 offset:2048
    ds_read_b64_tr_b16 v[234:235], v246 offset:3072
    v_add_f32 v253, v253, v11
    v_cvt_pk_bf16_f32 v9, v10, v11
    v_add_f32 v252, v252, v12
    v_add_f32 v253, v253, v13
    v_fmamk_f32 v175, v175, 0x3dd53b95, v250
    s_waitcnt lgkmcnt(4)
    v_mfma_f32_32x32x16_bf16 v[192:207], v[224:227], v[0:3], v[192:207]
    ds_read_b64_tr_b16 v[236:237], v247 offset:2048
    ds_read_b64_tr_b16 v[238:239], v248 offset:3072
    v_cvt_pk_bf16_f32 v10, v12, v13
    v_add_f32 v252, v252, v14
    v_add_f32 v253, v253, v15
    v_cvt_pk_bf16_f32 v11, v14, v15
    v_exp_f32 v174, v174
    v_add_f32 v252, v252, v144
    v_add_f32 v253, v253, v145
    s_waitcnt lgkmcnt(4)
    v_mfma_f32_32x32x16_bf16 v[208:223], v[228:231], v[0:3], v[208:223]
    ds_read_b64_tr_b16 v[224:225], v245 offset:10240
    ds_read_b64_tr_b16 v[226:227], v246 offset:11264
    v_cvt_pk_bf16_f32 v144, v144, v145
    ds_read_b128 v[84:87], v241 offset:1024
    s_waitcnt lgkmcnt(5)
    v_mfma_f32_32x32x16_bf16 v[16:31], v[232:235], v[8:11], v[16:31]
    ds_read_b64_tr_b16 v[228:229], v247 offset:10240
    ds_read_b64_tr_b16 v[230:231], v248 offset:11264
    v_mul_f32 v128, v255, v128
    v_mul_f32 v129, v255, v129
    v_mul_f32 v130, v255, v130
    v_mul_f32 v131, v255, v131
    v_exp_f32 v175, v175
    v_add_f32 v252, v252, v146
    s_waitcnt lgkmcnt(5)
    v_mfma_f32_32x32x16_bf16 v[32:47], v[236:239], v[8:11], v[32:47]
    ds_read_b64_tr_b16 v[232:233], v245 offset:18432
    ds_read_b64_tr_b16 v[234:235], v246 offset:19456
    v_mul_f32 v132, v255, v132
    v_mul_f32 v133, v255, v133
    v_mul_f32 v134, v255, v134
    v_mul_f32 v135, v255, v135
    v_add_f32 v253, v253, v147
    s_waitcnt lgkmcnt(5)
    v_mfma_f32_32x32x16_bf16 v[48:63], v[224:227], v[8:11], v[48:63]
    ds_read_b64_tr_b16 v[236:237], v247 offset:18432
    ds_read_b64_tr_b16 v[238:239], v248 offset:19456
    v_add_f32 v252, v252, v128
    v_add_f32 v253, v253, v129
    v_cvt_pk_bf16_f32 v128, v128, v129
    v_add_f32 v252, v252, v130
    v_cvt_pk_bf16_f32 v145, v146, v147
    v_add_f32 v252, v252, v152
    v_add_f32 v253, v253, v153
    s_waitcnt lgkmcnt(4)
    v_mfma_f32_32x32x16_bf16 v[176:191], v[228:231], v[8:11], v[176:191]
    ds_read_b64_tr_b16 v[224:225], v245 offset:4096
    ds_read_b64_tr_b16 v[226:227], v246 offset:5120
    v_add_f32 v253, v253, v131
    v_cvt_pk_bf16_f32 v129, v130, v131
    v_add_f32 v252, v252, v132
    v_add_f32 v253, v253, v133
    v_add_f32 v252, v252, v148
    v_add_f32 v253, v253, v149
    v_cvt_pk_bf16_f32 v152, v152, v153
    s_waitcnt lgkmcnt(4)
    v_mfma_f32_32x32x16_bf16 v[192:207], v[232:235], v[8:11], v[192:207]
    ds_read_b64_tr_b16 v[228:229], v247 offset:4096
    ds_read_b64_tr_b16 v[230:231], v248 offset:5120
    v_cvt_pk_bf16_f32 v130, v132, v133
    v_add_f32 v252, v252, v134
    v_add_f32 v253, v253, v135
    v_cvt_pk_bf16_f32 v131, v134, v135
    v_cvt_pk_bf16_f32 v146, v148, v149
    v_add_f32 v252, v252, v154
    s_waitcnt lgkmcnt(10)
    s_add_u32 s38, s39, 3072
    buffer_store_dwordx4 v[84:87], v242, s[24:27], s38 offen offset:0 nt
    s_waitcnt lgkmcnt(4)
    v_mfma_f32_32x32x16_bf16 v[208:223], v[236:239], v[8:11], v[208:223]
    ds_read_b64_tr_b16 v[232:233], v245 offset:12288
    ds_read_b64_tr_b16 v[234:235], v246 offset:13312
    v_add_f32 v252, v252, v150
    v_add_f32 v253, v253, v155
    s_waitcnt lgkmcnt(4)
    v_mfma_f32_32x32x16_bf16 v[16:31], v[224:227], v[128:131], v[16:31]
    ds_read_b64_tr_b16 v[236:237], v247 offset:12288
    ds_read_b64_tr_b16 v[238:239], v248 offset:13312
    v_mul_f32 v136, v255, v136
    v_mul_f32 v137, v255, v137
    v_mul_f32 v138, v255, v138
    v_mul_f32 v139, v255, v139
    v_add_f32 v253, v253, v151
    v_cvt_pk_bf16_f32 v153, v154, v155
    v_add_f32 v252, v252, v160
    v_add_f32 v253, v253, v161
    s_waitcnt lgkmcnt(4)
    v_mfma_f32_32x32x16_bf16 v[32:47], v[228:231], v[128:131], v[32:47]
    ds_read_b64_tr_b16 v[224:225], v245 offset:20480
    ds_read_b64_tr_b16 v[226:227], v246 offset:21504
    v_mul_f32 v140, v255, v140
    v_mul_f32 v141, v255, v141
    v_mul_f32 v142, v255, v142
    v_mul_f32 v143, v255, v143
    v_cvt_pk_bf16_f32 v147, v150, v151
    v_add_f32 v252, v252, v156
    v_add_f32 v253, v253, v157
    v_cvt_pk_bf16_f32 v160, v160, v161
    ds_read_b128 v[84:87], v241 offset:2048
    s_waitcnt lgkmcnt(5)
    v_mfma_f32_32x32x16_bf16 v[48:63], v[232:235], v[128:131], v[48:63]
    ds_read_b64_tr_b16 v[228:229], v247 offset:20480
    ds_read_b64_tr_b16 v[230:231], v248 offset:21504
    v_add_f32 v252, v252, v136
    v_add_f32 v253, v253, v137
    v_cvt_pk_bf16_f32 v136, v136, v137
    v_add_f32 v252, v252, v138
    v_cvt_pk_bf16_f32 v154, v156, v157
    v_add_f32 v252, v252, v162
    v_add_f32 v252, v252, v168
    v_add_f32 v253, v253, v169
    s_waitcnt lgkmcnt(5)
    v_mfma_f32_32x32x16_bf16 v[176:191], v[236:239], v[128:131], v[176:191]
    ds_read_b64_tr_b16 v[232:233], v245 offset:6144
    ds_read_b64_tr_b16 v[234:235], v246 offset:7168
    v_add_f32 v253, v253, v139
    v_cvt_pk_bf16_f32 v137, v138, v139
    v_add_f32 v252, v252, v140
    v_add_f32 v253, v253, v141
    v_add_f32 v252, v252, v158
    v_add_f32 v253, v253, v163
    v_cvt_pk_bf16_f32 v168, v168, v169
    s_waitcnt lgkmcnt(5)
    v_mfma_f32_32x32x16_bf16 v[192:207], v[224:227], v[128:131], v[192:207]
    ds_read_b64_tr_b16 v[236:237], v247 offset:6144
    ds_read_b64_tr_b16 v[238:239], v248 offset:7168
    v_cvt_pk_bf16_f32 v138, v140, v141
    v_add_f32 v252, v252, v142
    v_add_f32 v253, v253, v143
    v_cvt_pk_bf16_f32 v139, v142, v143
    v_add_f32 v253, v253, v159
    v_cvt_pk_bf16_f32 v161, v162, v163
    v_add_f32 v252, v252, v170
    s_waitcnt lgkmcnt(4)
    v_mfma_f32_32x32x16_bf16 v[208:223], v[228:231], v[128:131], v[208:223]
    ds_read_b64_tr_b16 v[224:225], v245 offset:14336
    ds_read_b64_tr_b16 v[226:227], v246 offset:15360
    v_cvt_pk_bf16_f32 v155, v158, v159
    v_add_f32 v252, v252, v164
    v_add_f32 v253, v253, v165
    v_add_f32 v253, v253, v171
    v_cvt_pk_bf16_f32 v169, v170, v171
    s_waitcnt lgkmcnt(4)
    v_mfma_f32_32x32x16_bf16 v[16:31], v[232:235], v[136:139], v[16:31]
    ds_read_b64_tr_b16 v[228:229], v247 offset:14336
    ds_read_b64_tr_b16 v[230:231], v248 offset:15360
    v_cvt_pk_bf16_f32 v162, v164, v165
    v_add_f32 v252, v252, v172
    s_waitcnt lgkmcnt(10)
    s_add_u32 s38, s39, 6144
    buffer_store_dwordx4 v[84:87], v242, s[24:27], s38 offen offset:0 nt
    s_waitcnt lgkmcnt(4)
    v_mfma_f32_32x32x16_bf16 v[32:47], v[236:239], v[136:139], v[32:47]
    ds_read_b64_tr_b16 v[232:233], v245 offset:22528
    ds_read_b64_tr_b16 v[234:235], v246 offset:23552
    v_add_f32 v252, v252, v166
    v_add_f32 v253, v253, v173
    s_waitcnt lgkmcnt(4)
    v_mfma_f32_32x32x16_bf16 v[48:63], v[224:227], v[136:139], v[48:63]
    ds_read_b64_tr_b16 v[236:237], v247 offset:22528
    ds_read_b64_tr_b16 v[238:239], v248 offset:23552
    v_add_f32 v253, v253, v167
    v_cvt_pk_bf16_f32 v170, v172, v173
    v_add_f32 v252, v252, v174
    s_waitcnt lgkmcnt(4)
    v_mfma_f32_32x32x16_bf16 v[176:191], v[228:231], v[136:139], v[176:191]
    s_waitcnt vmcnt(3)
    s_barrier
    v_add_u32 v245, 73728, v251
    v_xor_b32 v246, 16, v245
    v_xor_b32 v247, 64, v245
    v_xor_b32 v248, 0x50, v245
    ds_read_b64_tr_b16 v[224:225], v245 offset:16384
    ds_read_b64_tr_b16 v[226:227], v246 offset:17408
    v_cvt_pk_bf16_f32 v163, v166, v167
    v_add_f32 v253, v253, v175
    ds_read_b128 v[84:87], v241 offset:3072
    s_waitcnt lgkmcnt(5)
    v_mfma_f32_32x32x16_bf16 v[192:207], v[232:235], v[136:139], v[192:207]
    ds_read_b64_tr_b16 v[228:229], v245 offset:18432
    ds_read_b64_tr_b16 v[230:231], v246 offset:19456
    v_cvt_pk_bf16_f32 v171, v174, v175
    s_waitcnt lgkmcnt(5)
    v_mfma_f32_32x32x16_bf16 v[208:223], v[236:239], v[136:139], v[208:223]
    ds_read_b64_tr_b16 v[232:233], v245 offset:20480
    ds_read_b64_tr_b16 v[234:235], v246 offset:21504
    s_waitcnt lgkmcnt(5)
    v_mfma_f32_32x32x16_bf16 v[192:207], v[224:227], v[144:147], v[192:207]
    ds_read_b64_tr_b16 v[236:237], v245 offset:22528
    ds_read_b64_tr_b16 v[238:239], v246 offset:23552
    v_add_f32 v252, v252, v253
    v_mov_b32 v254, v252
    s_nop 1
    v_permlane32_swap_b32 v252, v254
    s_nop 1
    v_add_f32 v252, v252, v254
    v_rcp_f32 v243, v252
    s_waitcnt lgkmcnt(4)
    v_mfma_f32_32x32x16_bf16 v[192:207], v[228:231], v[152:155], v[192:207]
    ds_read_b64_tr_b16 v[224:225], v247 offset:16384
    ds_read_b64_tr_b16 v[226:227], v248 offset:17408
    s_waitcnt lgkmcnt(4)
    v_mfma_f32_32x32x16_bf16 v[192:207], v[232:235], v[160:163], v[192:207]
    ds_read_b64_tr_b16 v[228:229], v247 offset:18432
    ds_read_b64_tr_b16 v[230:231], v248 offset:19456
    s_waitcnt lgkmcnt(10)
    s_add_u32 s38, s39, 9216
    buffer_store_dwordx4 v[84:87], v242, s[24:27], s38 offen offset:0 nt
    s_waitcnt lgkmcnt(4)
    v_mfma_f32_32x32x16_bf16 v[192:207], v[236:239], v[168:171], v[192:207]
    ds_read_b64_tr_b16 v[232:233], v247 offset:20480
    ds_read_b64_tr_b16 v[234:235], v248 offset:21504
    s_waitcnt lgkmcnt(4)
    v_mfma_f32_32x32x16_bf16 v[208:223], v[224:227], v[144:147], v[208:223]
    ds_read_b64_tr_b16 v[236:237], v247 offset:22528
    ds_read_b64_tr_b16 v[238:239], v248 offset:23552
    s_waitcnt lgkmcnt(4)
    v_mfma_f32_32x32x16_bf16 v[208:223], v[228:231], v[152:155], v[208:223]
    ds_read_b64_tr_b16 v[224:225], v245 offset:8192
    ds_read_b64_tr_b16 v[226:227], v246 offset:9216
    s_waitcnt lgkmcnt(4)
    v_mfma_f32_32x32x16_bf16 v[208:223], v[232:235], v[160:163], v[208:223]
    ds_read_b64_tr_b16 v[228:229], v245 offset:10240
    ds_read_b64_tr_b16 v[230:231], v246 offset:11264
    s_waitcnt lgkmcnt(4)
    v_mfma_f32_32x32x16_bf16 v[208:223], v[236:239], v[168:171], v[208:223]
    ds_read_b64_tr_b16 v[232:233], v245 offset:12288
    ds_read_b64_tr_b16 v[234:235], v246 offset:13312
    s_waitcnt lgkmcnt(4)
    v_mfma_f32_32x32x16_bf16 v[48:63], v[224:227], v[144:147], v[48:63]
    ds_read_b64_tr_b16 v[236:237], v245 offset:14336
    ds_read_b64_tr_b16 v[238:239], v246 offset:15360
    s_waitcnt lgkmcnt(4)
    v_mfma_f32_32x32x16_bf16 v[48:63], v[228:231], v[152:155], v[48:63]
    ds_read_b64_tr_b16 v[224:225], v247 offset:8192
    ds_read_b64_tr_b16 v[226:227], v248 offset:9216
    s_waitcnt lgkmcnt(4)
    v_mfma_f32_32x32x16_bf16 v[48:63], v[232:235], v[160:163], v[48:63]
    ds_read_b64_tr_b16 v[228:229], v247 offset:10240
    ds_read_b64_tr_b16 v[230:231], v248 offset:11264
    s_waitcnt lgkmcnt(4)
    v_mfma_f32_32x32x16_bf16 v[48:63], v[236:239], v[168:171], v[48:63]
    ds_read_b64_tr_b16 v[232:233], v247 offset:12288
    ds_read_b64_tr_b16 v[234:235], v248 offset:13312
    v_mul_f32 v192, v243, v192
    v_mul_f32 v193, v243, v193
    v_mul_f32 v194, v243, v194
    v_mul_f32 v195, v243, v195
    v_cvt_pk_bf16_f32 v192, v192, v193
    v_cvt_pk_bf16_f32 v193, v194, v195
    ds_write_b64 v240, v[192:193]
    v_mul_f32 v196, v243, v196
    s_waitcnt lgkmcnt(5)
    v_mfma_f32_32x32x16_bf16 v[176:191], v[224:227], v[144:147], v[176:191]
    ds_read_b64_tr_b16 v[236:237], v247 offset:14336
    ds_read_b64_tr_b16 v[238:239], v248 offset:15360
    v_mul_f32 v197, v243, v197
    v_mul_f32 v198, v243, v198
    v_mul_f32 v199, v243, v199
    v_cvt_pk_bf16_f32 v196, v196, v197
    v_cvt_pk_bf16_f32 v197, v198, v199
    v_xor_b32 v254, 16, v240
    ds_write_b64 v254, v[196:197]
    v_mul_f32 v200, v243, v200
    s_waitcnt lgkmcnt(6)
    v_mfma_f32_32x32x16_bf16 v[176:191], v[228:231], v[152:155], v[176:191]
    ds_read_b64_tr_b16 v[224:225], v245 offset:0
    ds_read_b64_tr_b16 v[226:227], v246 offset:1024
    v_mul_f32 v201, v243, v201
    v_mul_f32 v202, v243, v202
    v_mul_f32 v203, v243, v203
    v_cvt_pk_bf16_f32 v200, v200, v201
    v_cvt_pk_bf16_f32 v201, v202, v203
    v_xor_b32 v254, 32, v240
    ds_write_b64 v254, v[200:201]
    v_mul_f32 v204, v243, v204
    s_waitcnt lgkmcnt(7)
    v_mfma_f32_32x32x16_bf16 v[176:191], v[232:235], v[160:163], v[176:191]
    ds_read_b64_tr_b16 v[228:229], v245 offset:2048
    ds_read_b64_tr_b16 v[230:231], v246 offset:3072
    v_mul_f32 v205, v243, v205
    v_mul_f32 v206, v243, v206
    v_mul_f32 v207, v243, v207
    v_cvt_pk_bf16_f32 v204, v204, v205
    v_cvt_pk_bf16_f32 v205, v206, v207
    v_xor_b32 v254, 48, v240
    ds_write_b64 v254, v[204:205]
    v_mul_f32 v208, v243, v208
    s_waitcnt lgkmcnt(7)
    v_mfma_f32_32x32x16_bf16 v[176:191], v[236:239], v[168:171], v[176:191]
    ds_read_b64_tr_b16 v[232:233], v245 offset:4096
    ds_read_b64_tr_b16 v[234:235], v246 offset:5120
    v_mul_f32 v209, v243, v209
    v_mul_f32 v210, v243, v210
    v_mul_f32 v211, v243, v211
    v_cvt_pk_bf16_f32 v208, v208, v209
    v_cvt_pk_bf16_f32 v209, v210, v211
    v_xor_b32 v254, 64, v240
    ds_write_b64 v254, v[208:209]
    v_mul_f32 v212, v243, v212
    s_waitcnt lgkmcnt(7)
    v_mfma_f32_32x32x16_bf16 v[16:31], v[224:227], v[144:147], v[16:31]
    ds_read_b64_tr_b16 v[236:237], v245 offset:6144
    ds_read_b64_tr_b16 v[238:239], v246 offset:7168
    v_mul_f32 v213, v243, v213
    v_mul_f32 v214, v243, v214
    v_mul_f32 v215, v243, v215
    v_cvt_pk_bf16_f32 v212, v212, v213
    v_cvt_pk_bf16_f32 v213, v214, v215
    v_xor_b32 v254, 80, v240
    ds_write_b64 v254, v[212:213]
    v_mul_f32 v216, v243, v216
    s_waitcnt lgkmcnt(7)
    v_mfma_f32_32x32x16_bf16 v[16:31], v[228:231], v[152:155], v[16:31]
    ds_read_b64_tr_b16 v[224:225], v247 offset:0
    ds_read_b64_tr_b16 v[226:227], v248 offset:1024
    v_mul_f32 v217, v243, v217
    v_mul_f32 v218, v243, v218
    v_mul_f32 v219, v243, v219
    v_cvt_pk_bf16_f32 v216, v216, v217
    v_cvt_pk_bf16_f32 v217, v218, v219
    v_xor_b32 v254, 96, v240
    ds_write_b64 v254, v[216:217]
    v_mul_f32 v220, v243, v220
    s_waitcnt lgkmcnt(7)
    v_mfma_f32_32x32x16_bf16 v[16:31], v[232:235], v[160:163], v[16:31]
    ds_read_b64_tr_b16 v[228:229], v247 offset:2048
    ds_read_b64_tr_b16 v[230:231], v248 offset:3072
    v_mul_f32 v221, v243, v221
    v_mul_f32 v222, v243, v222
    v_mul_f32 v223, v243, v223
    v_cvt_pk_bf16_f32 v220, v220, v221
    v_cvt_pk_bf16_f32 v221, v222, v223
    v_xor_b32 v254, 112, v240
    ds_write_b64 v254, v[220:221]
    s_waitcnt lgkmcnt(7)
    v_mfma_f32_32x32x16_bf16 v[16:31], v[236:239], v[168:171], v[16:31]
    ds_read_b64_tr_b16 v[232:233], v247 offset:4096
    ds_read_b64_tr_b16 v[234:235], v248 offset:5120
    ds_read_b128 v[80:83], v241 offset:0
    ds_read_b128 v[84:87], v241 offset:1024
    ds_read_b128 v[88:91], v241 offset:2048
    ds_read_b128 v[92:95], v241 offset:3072
    v_mul_f32 v48, v243, v48
    v_mul_f32 v49, v243, v49
    v_mul_f32 v50, v243, v50
    v_mul_f32 v51, v243, v51
    v_cvt_pk_bf16_f32 v48, v48, v49
    v_cvt_pk_bf16_f32 v49, v50, v51
    s_waitcnt lgkmcnt(10)
    v_mfma_f32_32x32x16_bf16 v[32:47], v[224:227], v[144:147], v[32:47]
    ds_read_b64_tr_b16 v[236:237], v247 offset:6144
    ds_read_b64_tr_b16 v[238:239], v248 offset:7168
    ds_write_b64 v240, v[48:49] offset:4096
    v_mul_f32 v52, v243, v52
    v_mul_f32 v53, v243, v53
    v_mul_f32 v54, v243, v54
    v_mul_f32 v55, v243, v55
    s_waitcnt lgkmcnt(10)
    v_mfma_f32_32x32x16_bf16 v[32:47], v[228:231], v[152:155], v[32:47]
    v_cvt_pk_bf16_f32 v52, v52, v53
    v_cvt_pk_bf16_f32 v53, v54, v55
    v_xor_b32 v254, 16, v240
    ds_write_b64 v254, v[52:53] offset:4096
    v_mul_f32 v56, v243, v56
    v_mul_f32 v57, v243, v57
    s_waitcnt lgkmcnt(8)
    v_mfma_f32_32x32x16_bf16 v[32:47], v[232:235], v[160:163], v[32:47]
    v_mul_f32 v58, v243, v58
    v_mul_f32 v59, v243, v59
    v_cvt_pk_bf16_f32 v56, v56, v57
    v_cvt_pk_bf16_f32 v57, v58, v59
    v_xor_b32 v254, 32, v240
    ds_write_b64 v254, v[56:57] offset:4096
    s_waitcnt lgkmcnt(3)
    v_mfma_f32_32x32x16_bf16 v[32:47], v[236:239], v[168:171], v[32:47]
    v_mul_f32 v60, v243, v60
    v_mul_f32 v61, v243, v61
    v_mul_f32 v62, v243, v62
    v_mul_f32 v63, v243, v63
    v_cvt_pk_bf16_f32 v60, v60, v61
    v_cvt_pk_bf16_f32 v61, v62, v63
    v_xor_b32 v254, 48, v240
    ds_write_b64 v254, v[60:61] offset:4096
    v_mul_f32 v176, v243, v176
    v_mul_f32 v177, v243, v177
    v_mul_f32 v178, v243, v178
    v_mul_f32 v179, v243, v179
    v_cvt_pk_bf16_f32 v176, v176, v177
    v_cvt_pk_bf16_f32 v177, v178, v179
    v_xor_b32 v254, 64, v240
    ds_write_b64 v254, v[176:177] offset:4096
    v_mul_f32 v180, v243, v180
    v_mul_f32 v181, v243, v181
    v_mul_f32 v182, v243, v182
    v_mul_f32 v183, v243, v183
    v_cvt_pk_bf16_f32 v180, v180, v181
    v_cvt_pk_bf16_f32 v181, v182, v183
    v_xor_b32 v254, 80, v240
    ds_write_b64 v254, v[180:181] offset:4096
    v_mul_f32 v184, v243, v184
    v_mul_f32 v185, v243, v185
    v_mul_f32 v186, v243, v186
    v_mul_f32 v187, v243, v187
    v_cvt_pk_bf16_f32 v184, v184, v185
    v_cvt_pk_bf16_f32 v185, v186, v187
    v_xor_b32 v254, 96, v240
    ds_write_b64 v254, v[184:185] offset:4096
    v_mul_f32 v188, v243, v188
    v_mul_f32 v189, v243, v189
    v_mul_f32 v190, v243, v190
    v_mul_f32 v191, v243, v191
    v_cvt_pk_bf16_f32 v188, v188, v189
    v_cvt_pk_bf16_f32 v189, v190, v191
    v_xor_b32 v254, 112, v240
    ds_write_b64 v254, v[188:189] offset:4096
    s_waitcnt lgkmcnt(13)
    s_add_u32 s38, s33, 0
    buffer_store_dwordx4 v[80:83], v242, s[24:27], s38 offen offset:256 nt
    s_waitcnt lgkmcnt(12)
    s_add_u32 s38, s33, 3072
    buffer_store_dwordx4 v[84:87], v242, s[24:27], s38 offen offset:256 nt
    ds_read_b128 v[96:99], v241 offset:4096
    ds_read_b128 v[100:103], v241 offset:5120
    ds_read_b128 v[104:107], v241 offset:6144
    ds_read_b128 v[108:111], v241 offset:7168
    v_mul_f32 v16, v243, v16
    v_mul_f32 v17, v243, v17
    v_mul_f32 v18, v243, v18
    v_mul_f32 v19, v243, v19
    v_cvt_pk_bf16_f32 v16, v16, v17
    v_cvt_pk_bf16_f32 v17, v18, v19
    ds_write_b64 v240, v[16:17]
    v_mul_f32 v20, v243, v20
    v_mul_f32 v21, v243, v21
    v_mul_f32 v22, v243, v22
    v_mul_f32 v23, v243, v23
    v_cvt_pk_bf16_f32 v20, v20, v21
    v_cvt_pk_bf16_f32 v21, v22, v23
    v_xor_b32 v254, 16, v240
    ds_write_b64 v254, v[20:21]
    v_mul_f32 v24, v243, v24
    v_mul_f32 v25, v243, v25
    v_mul_f32 v26, v243, v26
    v_mul_f32 v27, v243, v27
    v_cvt_pk_bf16_f32 v24, v24, v25
    v_cvt_pk_bf16_f32 v25, v26, v27
    v_xor_b32 v254, 32, v240
    ds_write_b64 v254, v[24:25]
    v_mul_f32 v28, v243, v28
    v_mul_f32 v29, v243, v29
    v_mul_f32 v30, v243, v30
    v_mul_f32 v31, v243, v31
    s_waitcnt lgkmcnt(15)
    s_add_u32 s38, s33, 6144
    buffer_store_dwordx4 v[88:91], v242, s[24:27], s38 offen offset:256 nt
    s_waitcnt lgkmcnt(15)
    s_add_u32 s38, s33, 9216
    buffer_store_dwordx4 v[92:95], v242, s[24:27], s38 offen offset:256 nt
    v_cvt_pk_bf16_f32 v28, v28, v29
    v_cvt_pk_bf16_f32 v29, v30, v31
    v_xor_b32 v254, 48, v240
    ds_write_b64 v254, v[28:29]
    v_mul_f32 v32, v243, v32
    v_mul_f32 v33, v243, v33
    v_mul_f32 v34, v243, v34
    v_mul_f32 v35, v243, v35
    v_cvt_pk_bf16_f32 v32, v32, v33
    v_cvt_pk_bf16_f32 v33, v34, v35
    v_xor_b32 v254, 64, v240
    ds_write_b64 v254, v[32:33]
    v_mul_f32 v36, v243, v36
    v_mul_f32 v37, v243, v37
    v_mul_f32 v38, v243, v38
    v_mul_f32 v39, v243, v39
    v_cvt_pk_bf16_f32 v36, v36, v37
    v_cvt_pk_bf16_f32 v37, v38, v39
    v_xor_b32 v254, 80, v240
    ds_write_b64 v254, v[36:37]
    v_mul_f32 v40, v243, v40
    v_mul_f32 v41, v243, v41
    v_mul_f32 v42, v243, v42
    v_mul_f32 v43, v243, v43
    v_cvt_pk_bf16_f32 v40, v40, v41
    v_cvt_pk_bf16_f32 v41, v42, v43
    v_xor_b32 v254, 96, v240
    ds_write_b64 v254, v[40:41]
    v_mul_f32 v44, v243, v44
    v_mul_f32 v45, v243, v45
    v_mul_f32 v46, v243, v46
    v_mul_f32 v47, v243, v47
    v_cvt_pk_bf16_f32 v44, v44, v45
    v_cvt_pk_bf16_f32 v45, v46, v47
    v_xor_b32 v254, 112, v240
    ds_write_b64 v254, v[44:45]
    s_waitcnt lgkmcnt(11)
    s_add_u32 s38, s33, 0
    buffer_store_dwordx4 v[96:99], v242, s[24:27], s38 offen offset:128 nt
    s_waitcnt lgkmcnt(10)
    s_add_u32 s38, s33, 3072
    buffer_store_dwordx4 v[100:103], v242, s[24:27], s38 offen offset:128 nt
    s_waitcnt lgkmcnt(9)
    s_add_u32 s38, s33, 6144
    buffer_store_dwordx4 v[104:107], v242, s[24:27], s38 offen offset:128 nt
    s_waitcnt lgkmcnt(8)
    s_add_u32 s38, s33, 9216
    buffer_store_dwordx4 v[108:111], v242, s[24:27], s38 offen offset:128 nt
    ds_read_b128 v[112:115], v241 offset:0
    ds_read_b128 v[116:119], v241 offset:1024
    ds_read_b128 v[120:123], v241 offset:2048
    ds_read_b128 v[124:127], v241 offset:3072
    s_waitcnt lgkmcnt(3)
    s_add_u32 s38, s33, 0
    buffer_store_dwordx4 v[112:115], v242, s[24:27], s38 offen offset:0 nt
    s_waitcnt lgkmcnt(2)
    s_add_u32 s38, s33, 3072
    buffer_store_dwordx4 v[116:119], v242, s[24:27], s38 offen offset:0 nt
    s_waitcnt lgkmcnt(1)
    s_add_u32 s38, s33, 6144
    buffer_store_dwordx4 v[120:123], v242, s[24:27], s38 offen offset:0 nt
    s_waitcnt lgkmcnt(0)
    s_add_u32 s38, s33, 9216
    buffer_store_dwordx4 v[124:127], v242, s[24:27], s38 offen offset:0 nt
L_end:
    s_endpgm
.section .rodata,"a"
.p2align 6
.amdhsa_kernel standalone__mha_softmax__near_ridge_kernel
  .amdhsa_next_free_vgpr 256
  .amdhsa_next_free_sgpr 48
  .amdhsa_accum_offset 256
  .amdhsa_group_segment_fixed_size 0
  .amdhsa_kernarg_size 48
  .amdhsa_user_sgpr_count 2
  .amdhsa_user_sgpr_kernarg_segment_ptr 1
  .amdhsa_system_sgpr_workgroup_id_x 1
.end_amdhsa_kernel
```
